```python
import torch

def _softmax(x, axis=-1):
    return torch.softmax(x, dim=axis)
def _gelu(x):
    return torch.nn.functional.gelu(x, approximate="tanh")
def _silu(x):
    return torch.nn.functional.silu(x)
def _sigmoid(x):
    return torch.sigmoid(x)
def _layernorm(x, axis=-1, eps=1e-5):
    m = x.mean(dim=axis, keepdim=True)
    v = x.var(dim=axis, keepdim=True, unbiased=False)
    return (x - m) / torch.sqrt(v + eps)
def _scatter_add(tgt, idx, src, axis=0):
    return tgt.clone().index_add_(axis, idx, src)
def _segment_sum(src, seg, n):
    out = torch.zeros((n,) + src.shape[1:], dtype=src.dtype)
    return out.index_add_(0, seg, src)
def _pad(x, pw):
    flat = tuple(v for pair in reversed(pw) for v in pair)
    return torch.nn.functional.pad(x, flat)

kernel_name = 'standalone__gqa_softmax__near_ridge'

def setup_inputs():

    _w = (lambda a: (lambda t: t.to(torch.bfloat16) if t.is_floating_point() else t)(torch.as_tensor(a)))
    B, Hq, Hkv, Sq, Sk, D = 8, 32, 32, 512, 1024, 128
    return {
        "q": _w((lambda *s: torch.randn(*s, dtype=torch.bfloat16) * 0.8)(B, Hq, Sq, D)),
        "k": _w((lambda *s: torch.randn(*s, dtype=torch.bfloat16) * 0.8)(B, Hkv, Sk, D)),
        "v": _w((lambda *s: torch.randn(*s, dtype=torch.bfloat16) * 0.05)(B, Hkv, Sk, D)),
    }

def reference(q, k, v):
    B, Hq, Sq, D = q.shape
    Hkv = k.shape[1]
    rep = Hq // Hkv
    k = (lambda x, n, axis: torch.repeat_interleave(x, n, dim=axis))(k, rep, axis=1)
    v = (lambda x, n, axis: torch.repeat_interleave(x, n, dim=axis))(v, rep, axis=1)
    scale = D ** -0.5
    scores = torch.einsum("bhqd,bhkd->bhqk", q, k) * scale
    p = _softmax(scores, axis=-1)
    return torch.einsum("bhqk,bhkd->bhqd", p, v)
```

```asm
; @launch grid=(256,1,1) block=(256,1,1) lds=163840
.amdgcn_target "amdgcn-amd-amdhsa--gfx950"
.text
.p2align 12
.globl standalone__gqa_softmax__near_ridge_kernel
.p2align 8
.type standalone__gqa_softmax__near_ridge_kernel,@function
standalone__gqa_softmax__near_ridge_kernel:
    s_cmp_ge_u32 s2, 256
    s_cbranch_scc1 END
    s_load_dwordx4 s[4:7], s[0:1], 0
    s_load_dwordx4 s[8:11], s[0:1], 16
    v_lshrrev_b32 v1, 6, v0
    v_and_b32 v0, 63, v0
    v_readfirstlane_b32 s39, v1
    s_lshr_b32 s42, s2, 4
    s_lshl_b32 s42, s42, 3
    s_and_b32 s43, s2, 7
    s_add_u32 s42, s42, s43
    s_lshr_b32 s43, s2, 3
    s_and_b32 s43, s43, 1
    s_lshl_b32 s44, s42, 19
    s_lshl_b32 s45, s42, 18
    s_lshl_b32 s43, s43, 16
    s_add_u32 s45, s45, s43
    s_lshl_b32 s46, s39, 12
    s_add_u32 s30, s46, 65536
    s_mul_i32 s36, s39, 12288
    v_bfe_u32 v116, v0, 2, 2
    v_lshrrev_b32 v117, 4, v0
    v_and_b32 v118, 3, v0
    v_lshlrev_b32 v10, 8, v116
    v_lshl_add_u32 v10, v117, 6, v10
    v_lshl_add_u32 v10, v118, 4, v10
    v_add_u32 v10, s46, v10
    v_xor_b32 v11, 48, v10
    v_xor_b32 v12, 32, v10
    v_xor_b32 v13, 16, v10
    s_lshl_b32 s47, s39, 14
    s_add_u32 s14, s47, 147456
    s_mov_b32 s15, 0x20000
    s_mov_b32 s18, 524288
    s_mov_b32 s19, 0x20000
    s_mov_b32 s22, 524288
    s_mov_b32 s23, 0x20000
    s_mov_b32 s26, 196608
    s_mov_b32 s27, 0x20000
    s_waitcnt lgkmcnt(0)
    s_add_u32 s16, s6, s44
    s_addc_u32 s17, s7, 0
    s_add_u32 s12, s4, s45
    s_addc_u32 s13, s5, 0
    s_add_u32 s20, s8, s44
    s_addc_u32 s21, s9, 0
    s_add_u32 s24, s10, s45
    s_addc_u32 s25, s11, 0
    s_add_u32 m0, s30, 0
    s_mov_b32 s29, 0
    buffer_load_dwordx4 v10, s[16:19], s29 offen offset:0 nt lds
    buffer_load_dwordx4 v11, s[16:19], s29 offen offset:1024 nt lds
    buffer_load_dwordx4 v12, s[16:19], s29 offen offset:2048 nt lds
    buffer_load_dwordx4 v13, s[16:19], s29 offen offset:3072 nt lds
    buffer_load_dwordx4 v[128:131], v10, s[12:15], s36 offen offset:0 nt
    buffer_load_dwordx4 v[132:135], v11, s[12:15], s36 offen offset:1024 nt
    buffer_load_dwordx4 v[136:139], v12, s[12:15], s36 offen offset:2048 nt
    buffer_load_dwordx4 v[140:143], v13, s[12:15], s36 offen offset:3072 nt
    s_add_u32 s36, s36, 4096
    buffer_load_dwordx4 v[160:163], v10, s[12:15], s36 offen offset:0 nt
    buffer_load_dwordx4 v[164:167], v11, s[12:15], s36 offen offset:1024 nt
    buffer_load_dwordx4 v[168:171], v12, s[12:15], s36 offen offset:2048 nt
    buffer_load_dwordx4 v[172:175], v13, s[12:15], s36 offen offset:3072 nt
    s_add_u32 s36, s36, 4096
    s_add_u32 s31, s30, 32768
    s_mov_b32 s28, 0x3e0293ee
    s_mov_b32 s40, s28
    s_mov_b32 s41, s28
    s_mov_b32 s34, 0xffff0000
    s_mov_b32 s35, 0x2f800000
    s_mov_b32 s38, 16384
    s_mov_b32 s37, 0
    v_sub_u32 v119, 0, v116
    v_and_b32 v119, 3, v119
    v_xor_b32 v119, v117, v119
    v_lshlrev_b32 v5, 10, v116
    v_lshl_add_u32 v5, v118, 6, v5
    v_lshl_add_u32 v5, v119, 4, v5
    v_add_u32 v2, 65536, v5
    v_add_u32 v5, s47, v5
    v_sub_u32 v119, 0, v117
    v_and_b32 v119, 3, v119
    v_lshrrev_b32 v120, 1, v118
    v_xor_b32 v119, v120, v119
    v_lshlrev_b32 v3, 10, v117
    v_lshl_add_u32 v3, v116, 6, v3
    v_lshl_add_u32 v3, v119, 4, v3
    v_and_b32 v120, 1, v0
    v_lshl_add_u32 v3, v120, 3, v3
    v_add_u32 v3, 114688, v3
    v_xor_b32 v4, 32, v3
    v_lshlrev_b32 v6, 4, v0
    v_add_u32 v6, s47, v6
    v_mov_b32 v15, v6
    v_and_b32 v119, 15, v0
    v_and_b32 v121, 7, v0
    v_lshrrev_b32 v120, 1, v117
    v_xor_b32 v120, v120, v121
    v_lshlrev_b32 v76, 7, v119
    v_lshl_add_u32 v76, v120, 4, v76
    v_and_b32 v120, 1, v117
    v_lshl_add_u32 v76, v120, 3, v76
    v_add_u32 v76, s47, v76
    v_xor_b32 v77, 32, v76
    v_xor_b32 v78, 64, v76
    v_xor_b32 v79, 96, v76
    v_xor_b32 v120, v117, v121
    v_lshlrev_b32 v8, 7, v117
    v_lshl_add_u32 v8, v120, 4, v8
    v_bfe_u32 v120, v0, 3, 1
    v_lshl_add_u32 v8, v120, 13, v8
    v_add_u32 v8, s47, v8
    v_xor_b32 v7, 64, v8
    v_mov_b32 v80, v8
    v_mov_b32 v81, v7
    v_mov_b32 v1, v10
    v_lshlrev_b32 v82, 8, v119
    v_and_b32 v120, 1, v117
    v_lshl_add_u32 v82, v120, 5, v82
    v_lshrrev_b32 v120, 1, v117
    v_lshl_add_u32 v82, v120, 4, v82
    v_add_u32 v82, s47, v82
    v_cmp_gt_u32 vcc, 2, v118
    v_mov_b32 v119, 0x3f803f80
    v_mov_b32 v9, 0
    v_cndmask_b32 v16, 0, v119, vcc
    v_cndmask_b32 v17, 0, v119, vcc
    v_cndmask_b32 v18, 0, v119, vcc
    v_cndmask_b32 v19, 0, v119, vcc
    v_cmp_eq_u32 vcc, 1, v118
    v_mov_b32 v14, 0x44444444
    v_mov_b32 v119, 0xeeeeeeee
    v_cndmask_b32 v14, v14, v119, vcc
    v_mov_b32 v52, 0
    v_mov_b32 v53, 0
    v_mov_b32 v54, 0
    v_mov_b32 v55, 0
    v_mov_b32 v56, 0
    v_mov_b32 v57, 0
    v_mov_b32 v58, 0
    v_mov_b32 v59, 0
    v_mov_b32 v60, 0
    v_mov_b32 v61, 0
    v_mov_b32 v62, 0
    v_mov_b32 v63, 0
    v_mov_b32 v64, 0
    v_mov_b32 v65, 0
    v_mov_b32 v66, 0
    v_mov_b32 v67, 0
    s_waitcnt vmcnt(8)
    s_barrier
    ds_read_b128 a[64:67], v2 offset:0
    ds_read_b128 a[68:71], v2 offset:256
    ds_read_b128 a[72:75], v2 offset:512
    ds_read_b128 a[76:79], v2 offset:768
    ds_read_b128 a[80:83], v2 offset:4096
    ds_read_b128 a[84:87], v2 offset:4352
    ds_read_b128 a[88:91], v2 offset:4608
    ds_read_b128 a[92:95], v2 offset:4864
    ds_read_b128 a[96:99], v2 offset:8192
    ds_read_b128 a[100:103], v2 offset:8448
    ds_read_b128 a[104:107], v2 offset:8704
    ds_read_b128 a[108:111], v2 offset:8960
    ds_read_b128 a[112:115], v2 offset:12288
    ds_read_b128 a[116:119], v2 offset:12544
    ds_read_b128 a[120:123], v2 offset:12800
    ds_read_b128 a[124:127], v2 offset:13056
    s_waitcnt vmcnt(7)
    s_add_u32 m0, s30, 49152
    s_mov_b32 s29, 0
    buffer_load_dwordx4 v10, s[20:23], s29 offen offset:0 nt lds
    buffer_load_dwordx4 v11, s[20:23], s29 offen offset:1024 nt lds
    buffer_load_dwordx4 v12, s[20:23], s29 offen offset:2048 nt lds
    buffer_load_dwordx4 v13, s[20:23], s29 offen offset:3072 nt lds
    buffer_load_dwordx4 v[192:195], v10, s[12:15], s36 offen offset:0 nt
    buffer_load_dwordx4 v[196:199], v11, s[12:15], s36 offen offset:1024 nt
    buffer_load_dwordx4 v[200:203], v12, s[12:15], s36 offen offset:2048 nt
    buffer_load_dwordx4 v[204:207], v13, s[12:15], s36 offen offset:3072 nt
    s_add_u32 s36, s36, 4096
    v_lshlrev_b32 v116, 16, v128
    v_and_b32 v117, s34, v128
    v_pk_mul_f32 v[116:117], v[116:117], s[40:41]
    v_cvt_pk_bf16_f32 v128, v116, v117
    v_lshlrev_b32 v118, 16, v129
    v_and_b32 v119, s34, v129
    v_pk_mul_f32 v[118:119], v[118:119], s[40:41]
    v_cvt_pk_bf16_f32 v129, v118, v119
    v_lshlrev_b32 v116, 16, v130
    v_and_b32 v117, s34, v130
    v_pk_mul_f32 v[116:117], v[116:117], s[40:41]
    v_cvt_pk_bf16_f32 v130, v116, v117
    v_lshlrev_b32 v118, 16, v131
    v_and_b32 v119, s34, v131
    v_pk_mul_f32 v[118:119], v[118:119], s[40:41]
    v_cvt_pk_bf16_f32 v131, v118, v119
    ds_write_b128 v6, v[128:131] offset:0
    s_waitcnt vmcnt(14)
    v_lshlrev_b32 v116, 16, v132
    v_and_b32 v117, s34, v132
    v_pk_mul_f32 v[116:117], v[116:117], s[40:41]
    v_cvt_pk_bf16_f32 v132, v116, v117
    v_lshlrev_b32 v118, 16, v133
    v_and_b32 v119, s34, v133
    v_pk_mul_f32 v[118:119], v[118:119], s[40:41]
    v_cvt_pk_bf16_f32 v133, v118, v119
    v_lshlrev_b32 v116, 16, v134
    v_and_b32 v117, s34, v134
    v_pk_mul_f32 v[116:117], v[116:117], s[40:41]
    v_cvt_pk_bf16_f32 v134, v116, v117
    v_lshlrev_b32 v118, 16, v135
    v_and_b32 v119, s34, v135
    v_pk_mul_f32 v[118:119], v[118:119], s[40:41]
    v_cvt_pk_bf16_f32 v135, v118, v119
    ds_write_b128 v6, v[132:135] offset:1024
    s_waitcnt vmcnt(13)
    v_lshlrev_b32 v116, 16, v136
    v_and_b32 v117, s34, v136
    v_pk_mul_f32 v[116:117], v[116:117], s[40:41]
    v_cvt_pk_bf16_f32 v136, v116, v117
    v_lshlrev_b32 v118, 16, v137
    v_and_b32 v119, s34, v137
    v_pk_mul_f32 v[118:119], v[118:119], s[40:41]
    v_cvt_pk_bf16_f32 v137, v118, v119
    v_lshlrev_b32 v116, 16, v138
    v_and_b32 v117, s34, v138
    v_pk_mul_f32 v[116:117], v[116:117], s[40:41]
    v_cvt_pk_bf16_f32 v138, v116, v117
    v_lshlrev_b32 v118, 16, v139
    v_and_b32 v119, s34, v139
    v_pk_mul_f32 v[118:119], v[118:119], s[40:41]
    v_cvt_pk_bf16_f32 v139, v118, v119
    ds_write_b128 v6, v[136:139] offset:2048
    s_waitcnt vmcnt(12)
    v_lshlrev_b32 v116, 16, v140
    v_and_b32 v117, s34, v140
    v_pk_mul_f32 v[116:117], v[116:117], s[40:41]
    v_cvt_pk_bf16_f32 v140, v116, v117
    v_lshlrev_b32 v118, 16, v141
    v_and_b32 v119, s34, v141
    v_pk_mul_f32 v[118:119], v[118:119], s[40:41]
    v_cvt_pk_bf16_f32 v141, v118, v119
    v_lshlrev_b32 v116, 16, v142
    v_and_b32 v117, s34, v142
    v_pk_mul_f32 v[116:117], v[116:117], s[40:41]
    v_cvt_pk_bf16_f32 v142, v116, v117
    v_lshlrev_b32 v118, 16, v143
    v_and_b32 v119, s34, v143
    v_pk_mul_f32 v[118:119], v[118:119], s[40:41]
    v_cvt_pk_bf16_f32 v143, v118, v119
    ds_write_b128 v6, v[140:143] offset:3072
    ds_read_b128 a[0:3], v5 offset:0
    ds_read_b128 a[4:7], v5 offset:256
    ds_read_b128 a[8:11], v5 offset:512
    ds_read_b128 a[12:15], v5 offset:768
    s_waitcnt lgkmcnt(3)
    v_mfma_f32_16x16x32_bf16 v[20:23], a[64:67], a[0:3], 0
    s_waitcnt lgkmcnt(0)
    v_mfma_f32_16x16x32_bf16 v[20:23], a[68:71], a[4:7], v[20:23]
    v_mfma_f32_16x16x32_bf16 v[20:23], a[72:75], a[8:11], v[20:23]
    v_mfma_f32_16x16x32_bf16 v[20:23], a[76:79], a[12:15], v[20:23]
    v_mfma_f32_16x16x32_bf16 v[24:27], a[80:83], a[0:3], 0
    v_mfma_f32_16x16x32_bf16 v[24:27], a[84:87], a[4:7], v[24:27]
    v_mfma_f32_16x16x32_bf16 v[24:27], a[88:91], a[8:11], v[24:27]
    v_mfma_f32_16x16x32_bf16 v[24:27], a[92:95], a[12:15], v[24:27]
    v_mfma_f32_16x16x32_bf16 v[28:31], a[96:99], a[0:3], 0
    v_mfma_f32_16x16x32_bf16 v[28:31], a[100:103], a[4:7], v[28:31]
    v_mfma_f32_16x16x32_bf16 v[28:31], a[104:107], a[8:11], v[28:31]
    v_mfma_f32_16x16x32_bf16 v[28:31], a[108:111], a[12:15], v[28:31]
    v_exp_f32 v20, v20
    v_mfma_f32_16x16x32_bf16 v[32:35], a[112:115], a[0:3], 0
    v_exp_f32 v21, v21
    v_mfma_f32_16x16x32_bf16 v[32:35], a[116:119], a[4:7], v[32:35]
    v_exp_f32 v22, v22
    v_mfma_f32_16x16x32_bf16 v[32:35], a[120:123], a[8:11], v[32:35]
    v_exp_f32 v23, v23
    v_mfma_f32_16x16x32_bf16 v[32:35], a[124:127], a[12:15], v[32:35]
    v_exp_f32 v24, v24
    v_cvt_pk_bf16_f32 v44, v20, v21
    v_exp_f32 v25, v25
    v_exp_f32 v26, v26
    v_cvt_pk_bf16_f32 v45, v22, v23
    v_exp_f32 v27, v27
    v_exp_f32 v28, v28
    v_cvt_pk_bf16_f32 v46, v24, v25
    v_exp_f32 v29, v29
    v_exp_f32 v30, v30
    v_cvt_pk_bf16_f32 v47, v26, v27
    v_exp_f32 v31, v31
    v_cvt_pk_bf16_f32 v48, v28, v29
    v_cvt_pk_bf16_f32 v49, v30, v31
    s_waitcnt vmcnt(11)
    buffer_load_dwordx4 v[224:227], v10, s[12:15], s36 offen offset:0 nt
    buffer_load_dwordx4 v[228:231], v11, s[12:15], s36 offen offset:1024 nt
    buffer_load_dwordx4 v[232:235], v12, s[12:15], s36 offen offset:2048 nt
    buffer_load_dwordx4 v[236:239], v13, s[12:15], s36 offen offset:3072 nt
    s_add_u32 s36, s36, 4096
    s_add_u32 m0, s30, 16384
    s_mov_b32 s29, 16384
    buffer_load_dwordx4 v10, s[16:19], s29 offen offset:0 nt lds
    buffer_load_dwordx4 v11, s[16:19], s29 offen offset:1024 nt lds
    buffer_load_dwordx4 v12, s[16:19], s29 offen offset:2048 nt lds
    buffer_load_dwordx4 v13, s[16:19], s29 offen offset:3072 nt lds
    v_lshlrev_b32 v116, 16, v160
    v_and_b32 v117, s34, v160
    v_pk_mul_f32 v[116:117], v[116:117], s[40:41]
    v_cvt_pk_bf16_f32 v160, v116, v117
    v_lshlrev_b32 v118, 16, v161
    v_and_b32 v119, s34, v161
    v_pk_mul_f32 v[118:119], v[118:119], s[40:41]
    v_cvt_pk_bf16_f32 v161, v118, v119
    v_lshlrev_b32 v116, 16, v162
    v_and_b32 v117, s34, v162
    v_pk_mul_f32 v[116:117], v[116:117], s[40:41]
    v_cvt_pk_bf16_f32 v162, v116, v117
    v_lshlrev_b32 v118, 16, v163
    v_and_b32 v119, s34, v163
    v_pk_mul_f32 v[118:119], v[118:119], s[40:41]
    v_cvt_pk_bf16_f32 v163, v118, v119
    ds_write_b128 v6, v[160:163] offset:4096
    s_waitcnt vmcnt(18)
    v_lshlrev_b32 v116, 16, v164
    v_and_b32 v117, s34, v164
    v_pk_mul_f32 v[116:117], v[116:117], s[40:41]
    v_cvt_pk_bf16_f32 v164, v116, v117
    v_lshlrev_b32 v118, 16, v165
    v_and_b32 v119, s34, v165
    v_pk_mul_f32 v[118:119], v[118:119], s[40:41]
    v_cvt_pk_bf16_f32 v165, v118, v119
    v_lshlrev_b32 v116, 16, v166
    v_and_b32 v117, s34, v166
    v_pk_mul_f32 v[116:117], v[116:117], s[40:41]
    v_cvt_pk_bf16_f32 v166, v116, v117
    v_lshlrev_b32 v118, 16, v167
    v_and_b32 v119, s34, v167
    v_pk_mul_f32 v[118:119], v[118:119], s[40:41]
    v_cvt_pk_bf16_f32 v167, v118, v119
    ds_write_b128 v6, v[164:167] offset:5120
    s_waitcnt vmcnt(17)
    v_lshlrev_b32 v116, 16, v168
    v_and_b32 v117, s34, v168
    v_pk_mul_f32 v[116:117], v[116:117], s[40:41]
    v_cvt_pk_bf16_f32 v168, v116, v117
    v_lshlrev_b32 v118, 16, v169
    v_and_b32 v119, s34, v169
    v_pk_mul_f32 v[118:119], v[118:119], s[40:41]
    v_cvt_pk_bf16_f32 v169, v118, v119
    v_lshlrev_b32 v116, 16, v170
    v_and_b32 v117, s34, v170
    v_pk_mul_f32 v[116:117], v[116:117], s[40:41]
    v_cvt_pk_bf16_f32 v170, v116, v117
    v_lshlrev_b32 v118, 16, v171
    v_and_b32 v119, s34, v171
    v_pk_mul_f32 v[118:119], v[118:119], s[40:41]
    v_cvt_pk_bf16_f32 v171, v118, v119
    ds_write_b128 v6, v[168:171] offset:6144
    s_waitcnt vmcnt(16)
    v_lshlrev_b32 v116, 16, v172
    v_and_b32 v117, s34, v172
    v_pk_mul_f32 v[116:117], v[116:117], s[40:41]
    v_cvt_pk_bf16_f32 v172, v116, v117
    v_lshlrev_b32 v118, 16, v173
    v_and_b32 v119, s34, v173
    v_pk_mul_f32 v[118:119], v[118:119], s[40:41]
    v_cvt_pk_bf16_f32 v173, v118, v119
    v_lshlrev_b32 v116, 16, v174
    v_and_b32 v117, s34, v174
    v_pk_mul_f32 v[116:117], v[116:117], s[40:41]
    v_cvt_pk_bf16_f32 v174, v116, v117
    v_lshlrev_b32 v118, 16, v175
    v_and_b32 v119, s34, v175
    v_pk_mul_f32 v[118:119], v[118:119], s[40:41]
    v_cvt_pk_bf16_f32 v175, v118, v119
    ds_write_b128 v6, v[172:175] offset:7168
    ds_read_b128 a[16:19], v5 offset:4096
    ds_read_b128 a[20:23], v5 offset:4352
    ds_read_b128 a[24:27], v5 offset:4608
    ds_read_b128 a[28:31], v5 offset:4864
    s_mov_b64 vcc, -1
    s_cmp_eq_u32 s39, 0
    s_cbranch_scc1 PG1
    s_cmp_eq_u32 s39, 1
    s_cbranch_scc1 PG2
    s_cmp_eq_u32 s39, 2
    s_cbranch_scc1 PG3
    s_branch PG4
.p2align 12
BODY:
    s_mov_b64 vcc, 0
    s_waitcnt vmcnt(12)
    s_barrier
    s_add_u32 m0, s30, 65536
    s_mov_b32 s29, 16384
    buffer_load_dwordx4 v10, s[20:23], s29 offen offset:0 nt lds
    buffer_load_dwordx4 v11, s[20:23], s29 offen offset:1024 nt lds
    buffer_load_dwordx4 v12, s[20:23], s29 offen offset:2048 nt lds
    buffer_load_dwordx4 v13, s[20:23], s29 offen offset:3072 nt lds
    ds_read_b64_tr_b16 a[128:129], v3 offset:0
    ds_read_b64_tr_b16 a[130:131], v3 offset:4096
    ds_read_b64_tr_b16 a[132:133], v3 offset:8192
    ds_read_b64_tr_b16 a[134:135], v3 offset:12288
    ds_read_b64_tr_b16 a[136:137], v4 offset:0
    ds_read_b64_tr_b16 a[138:139], v4 offset:4096
    ds_read_b64_tr_b16 a[140:141], v4 offset:8192
    ds_read_b64_tr_b16 a[142:143], v4 offset:12288
    ds_read_b64_tr_b16 a[144:145], v3 offset:256
    ds_read_b64_tr_b16 a[146:147], v3 offset:4352
    ds_read_b64_tr_b16 a[148:149], v3 offset:8448
    ds_read_b64_tr_b16 a[150:151], v3 offset:12544
    ds_read_b64_tr_b16 a[152:153], v4 offset:256
    ds_read_b64_tr_b16 a[154:155], v4 offset:4352
    ds_read_b64_tr_b16 a[156:157], v4 offset:8448
    ds_read_b64_tr_b16 a[158:159], v4 offset:12544
    ds_read_b64_tr_b16 a[160:161], v3 offset:512
    ds_read_b64_tr_b16 a[162:163], v3 offset:4608
    ds_read_b64_tr_b16 a[164:165], v3 offset:8704
    ds_read_b64_tr_b16 a[166:167], v3 offset:12800
    ds_read_b64_tr_b16 a[168:169], v4 offset:512
    ds_read_b64_tr_b16 a[170:171], v4 offset:4608
    ds_read_b64_tr_b16 a[172:173], v4 offset:8704
    ds_read_b64_tr_b16 a[174:175], v4 offset:12800
    ds_read_b64_tr_b16 a[176:177], v3 offset:768
    ds_read_b64_tr_b16 a[178:179], v3 offset:4864
    ds_read_b64_tr_b16 a[180:181], v3 offset:8960
    ds_read_b64_tr_b16 a[182:183], v3 offset:13056
    ds_read_b64_tr_b16 a[184:185], v4 offset:768
    ds_read_b64_tr_b16 a[186:187], v4 offset:4864
    ds_read_b64_tr_b16 a[188:189], v4 offset:8960
    ds_read_b64_tr_b16 a[190:191], v4 offset:13056
    s_waitcnt lgkmcnt(15)
    v_mfma_f32_16x16x32_bf16 v[20:23], a[64:67], a[16:19], 0
    v_exp_f32 v32, v32
    v_mfma_f32_16x16x32_bf16 v[20:23], a[68:71], a[20:23], v[20:23]
    s_waitcnt vmcnt(15)
    v_lshlrev_b32 v116, 16, v192
    v_and_b32 v117, s34, v192
    v_mul_f32 v116, s28, v116
    v_mul_f32 v117, s28, v117
    v_cvt_pk_bf16_f32 v192, v116, v117
    v_lshlrev_b32 v118, 16, v193
    v_mfma_f32_16x16x32_bf16 v[20:23], a[72:75], a[24:27], v[20:23]
    v_exp_f32 v33, v33
    v_mfma_f32_16x16x32_bf16 v[20:23], a[76:79], a[28:31], v[20:23]
    v_cvt_pk_bf16_f32 v50, v32, v33
    v_and_b32 v119, s34, v193
    v_mul_f32 v118, s28, v118
    v_mul_f32 v119, s28, v119
    v_cvt_pk_bf16_f32 v193, v118, v119
    v_lshlrev_b32 v116, 16, v194
    v_and_b32 v117, s34, v194
    v_mfma_f32_16x16x32_bf16 v[24:27], a[80:83], a[16:19], 0
    v_exp_f32 v34, v34
    v_mfma_f32_16x16x32_bf16 v[24:27], a[84:87], a[20:23], v[24:27]
    v_mul_f32 v116, s28, v116
    v_mul_f32 v117, s28, v117
    v_cvt_pk_bf16_f32 v194, v116, v117
    v_lshlrev_b32 v118, 16, v195
    v_and_b32 v119, s34, v195
    v_mul_f32 v118, s28, v118
    v_mul_f32 v119, s28, v119
    v_mfma_f32_16x16x32_bf16 v[24:27], a[88:91], a[24:27], v[24:27]
    v_exp_f32 v35, v35
    v_mfma_f32_16x16x32_bf16 v[24:27], a[92:95], a[28:31], v[24:27]
    v_cvt_pk_bf16_f32 v51, v34, v35
    v_cvt_pk_bf16_f32 v195, v118, v119
    ds_write_b128 v6, v[192:195] offset:8192
    s_waitcnt vmcnt(14)
    v_lshlrev_b32 v116, 16, v196
    v_and_b32 v117, s34, v196
    v_mul_f32 v116, s28, v116
    v_mul_f32 v117, s28, v117
    v_mfma_f32_16x16x32_bf16 v[28:31], a[96:99], a[16:19], 0
    v_exp_f32 v20, v20
    v_mfma_f32_16x16x32_bf16 v[28:31], a[100:103], a[20:23], v[28:31]
    v_cvt_pk_bf16_f32 v196, v116, v117
    v_lshlrev_b32 v118, 16, v197
    v_and_b32 v119, s34, v197
    v_mul_f32 v118, s28, v118
    v_mul_f32 v119, s28, v119
    v_cvt_pk_bf16_f32 v197, v118, v119
    v_lshlrev_b32 v116, 16, v198
    v_mfma_f32_16x16x32_bf16 v[28:31], a[104:107], a[24:27], v[28:31]
    v_exp_f32 v21, v21
    v_mfma_f32_16x16x32_bf16 v[28:31], a[108:111], a[28:31], v[28:31]
    v_cvt_pk_bf16_f32 v36, v20, v21
    v_and_b32 v117, s34, v198
    v_mul_f32 v116, s28, v116
    v_mul_f32 v117, s28, v117
    v_cvt_pk_bf16_f32 v198, v116, v117
    v_lshlrev_b32 v118, 16, v199
    v_and_b32 v119, s34, v199
    v_mfma_f32_16x16x32_bf16 v[32:35], a[112:115], a[16:19], 0
    v_exp_f32 v22, v22
    v_mfma_f32_16x16x32_bf16 v[32:35], a[116:119], a[20:23], v[32:35]
    v_mul_f32 v118, s28, v118
    v_mul_f32 v119, s28, v119
    v_cvt_pk_bf16_f32 v199, v118, v119
    ds_write_b128 v6, v[196:199] offset:9216
    s_waitcnt vmcnt(13)
    v_lshlrev_b32 v116, 16, v200
    v_and_b32 v117, s34, v200
    v_mfma_f32_16x16x32_bf16 v[32:35], a[120:123], a[24:27], v[32:35]
    v_exp_f32 v23, v23
    v_mfma_f32_16x16x32_bf16 v[32:35], a[124:127], a[28:31], v[32:35]
    v_cvt_pk_bf16_f32 v37, v22, v23
    s_waitcnt lgkmcnt(2)
    v_mul_f32 v116, s28, v116
    v_mul_f32 v117, s28, v117
    v_cvt_pk_bf16_f32 v200, v116, v117
    v_lshlrev_b32 v118, 16, v201
    v_and_b32 v119, s34, v201
    v_mfma_f32_16x16x32_bf16 v[128:131], a[128:131], v[44:47], 0
    v_exp_f32 v24, v24
    v_mfma_f32_16x16x32_bf16 v[128:131], a[132:135], v[48:51], v[128:131]
    v_mul_f32 v118, s28, v118
    v_mul_f32 v119, s28, v119
    v_cvt_pk_bf16_f32 v201, v118, v119
    v_lshlrev_b32 v116, 16, v202
    v_and_b32 v117, s34, v202
    v_mul_f32 v116, s28, v116
    v_mul_f32 v117, s28, v117
    v_mfma_f32_16x16x32_bf16 v[132:135], a[136:139], v[44:47], 0
    v_exp_f32 v25, v25
    v_mfma_f32_16x16x32_bf16 v[132:135], a[140:143], v[48:51], v[132:135]
    v_cvt_pk_bf16_f32 v38, v24, v25
    v_cvt_pk_bf16_f32 v202, v116, v117
    v_lshlrev_b32 v118, 16, v203
    v_and_b32 v119, s34, v203
    v_mul_f32 v118, s28, v118
    v_mul_f32 v119, s28, v119
    v_cvt_pk_bf16_f32 v203, v118, v119
    v_mfma_f32_16x16x32_bf16 v[136:139], a[144:147], v[44:47], 0
    v_exp_f32 v26, v26
    v_mfma_f32_16x16x32_bf16 v[136:139], a[148:151], v[48:51], v[136:139]
    ds_write_b128 v6, v[200:203] offset:10240
    s_waitcnt vmcnt(12)
    v_lshlrev_b32 v116, 16, v204
    v_and_b32 v117, s34, v204
    v_mul_f32 v116, s28, v116
    v_mul_f32 v117, s28, v117
    v_cvt_pk_bf16_f32 v204, v116, v117
    v_lshlrev_b32 v118, 16, v205
    v_mfma_f32_16x16x32_bf16 v[140:143], a[152:155], v[44:47], 0
    v_exp_f32 v27, v27
    v_mfma_f32_16x16x32_bf16 v[140:143], a[156:159], v[48:51], v[140:143]
    v_cvt_pk_bf16_f32 v39, v26, v27
    v_and_b32 v119, s34, v205
    v_mul_f32 v118, s28, v118
    v_mul_f32 v119, s28, v119
    v_cvt_pk_bf16_f32 v205, v118, v119
    v_lshlrev_b32 v116, 16, v206
    v_and_b32 v117, s34, v206
    v_mfma_f32_16x16x32_bf16 v[144:147], a[160:163], v[44:47], 0
    v_exp_f32 v28, v28
    v_mfma_f32_16x16x32_bf16 v[144:147], a[164:167], v[48:51], v[144:147]
    v_mul_f32 v116, s28, v116
    v_mul_f32 v117, s28, v117
    v_cvt_pk_bf16_f32 v206, v116, v117
    v_lshlrev_b32 v118, 16, v207
    v_and_b32 v119, s34, v207
    v_mul_f32 v118, s28, v118
    v_mul_f32 v119, s28, v119
    v_mfma_f32_16x16x32_bf16 v[148:151], a[168:171], v[44:47], 0
    v_exp_f32 v29, v29
    v_mfma_f32_16x16x32_bf16 v[148:151], a[172:175], v[48:51], v[148:151]
    v_cvt_pk_bf16_f32 v40, v28, v29
    v_cvt_pk_bf16_f32 v207, v118, v119
    ds_write_b128 v6, v[204:207] offset:11264
    ds_read_b128 a[32:35], v5 offset:8192
    ds_read_b128 a[36:39], v5 offset:8448
    ds_read_b128 a[40:43], v5 offset:8704
    ds_read_b128 a[44:47], v5 offset:8960
    v_mfma_f32_16x16x32_bf16 v[152:155], a[176:179], v[44:47], 0
    v_exp_f32 v30, v30
    v_mfma_f32_16x16x32_bf16 v[152:155], a[180:183], v[48:51], v[152:155]
    v_mfma_f32_16x16x32_bf16 v[156:159], a[184:187], v[44:47], 0
    v_exp_f32 v31, v31
    v_mfma_f32_16x16x32_bf16 v[156:159], a[188:191], v[48:51], v[156:159]
    v_cvt_pk_bf16_f32 v41, v30, v31
    v_smfmac_f32_16x16x64_bf16 v[52:55], v[16:19], v[44:51], v14
    s_waitcnt lgkmcnt(0)
    v_mfma_f32_16x16x32_bf16 v[20:23], a[64:67], a[32:35], 0
    v_exp_f32 v32, v32
    v_mfma_f32_16x16x32_bf16 v[20:23], a[68:71], a[36:39], v[20:23]
    s_waitcnt vmcnt(11)
    s_add_u32 m0, s30, 32768
    s_mov_b32 s29, 32768
    buffer_load_dwordx4 v10, s[16:19], s29 offen offset:0 nt lds
    buffer_load_dwordx4 v11, s[16:19], s29 offen offset:1024 nt lds
    buffer_load_dwordx4 v12, s[16:19], s29 offen offset:2048 nt lds
    v_mfma_f32_16x16x32_bf16 v[20:23], a[72:75], a[40:43], v[20:23]
    v_exp_f32 v33, v33
    v_mfma_f32_16x16x32_bf16 v[20:23], a[76:79], a[44:47], v[20:23]
    v_cvt_pk_bf16_f32 v42, v32, v33
    buffer_load_dwordx4 v13, s[16:19], s29 offen offset:3072 nt lds
    s_add_u32 m0, s30, 81920
    s_mov_b32 s29, 32768
    buffer_load_dwordx4 v10, s[20:23], s29 offen offset:0 nt lds
    buffer_load_dwordx4 v11, s[20:23], s29 offen offset:1024 nt lds
    v_mfma_f32_16x16x32_bf16 v[24:27], a[80:83], a[32:35], 0
    v_exp_f32 v34, v34
    v_mfma_f32_16x16x32_bf16 v[24:27], a[84:87], a[36:39], v[24:27]
    buffer_load_dwordx4 v12, s[20:23], s29 offen offset:2048 nt lds
    buffer_load_dwordx4 v13, s[20:23], s29 offen offset:3072 nt lds
    s_mov_b32 s29, 49152
    v_lshlrev_b32 v116, 16, v224
    v_and_b32 v117, s34, v224
    v_mul_f32 v116, s28, v116
    v_mfma_f32_16x16x32_bf16 v[24:27], a[88:91], a[40:43], v[24:27]
    v_exp_f32 v35, v35
    v_mfma_f32_16x16x32_bf16 v[24:27], a[92:95], a[44:47], v[24:27]
    v_cvt_pk_bf16_f32 v43, v34, v35
    v_mul_f32 v117, s28, v117
    v_cvt_pk_bf16_f32 v224, v116, v117
    v_lshlrev_b32 v118, 16, v225
    v_and_b32 v119, s34, v225
    v_mul_f32 v118, s28, v118
    v_mul_f32 v119, s28, v119
    v_cvt_pk_bf16_f32 v225, v118, v119
    v_mfma_f32_16x16x32_bf16 v[28:31], a[96:99], a[32:35], 0
    v_exp_f32 v20, v20
    v_mfma_f32_16x16x32_bf16 v[28:31], a[100:103], a[36:39], v[28:31]
    v_lshlrev_b32 v116, 16, v226
    v_and_b32 v117, s34, v226
    v_mul_f32 v116, s28, v116
    v_mul_f32 v117, s28, v117
    v_cvt_pk_bf16_f32 v226, v116, v117
    v_lshlrev_b32 v118, 16, v227
    v_and_b32 v119, s34, v227
    v_mul_f32 v118, s28, v118
    v_mul_f32 v119, s28, v119
    v_mfma_f32_16x16x32_bf16 v[28:31], a[104:107], a[40:43], v[28:31]
    v_exp_f32 v21, v21
    v_mfma_f32_16x16x32_bf16 v[28:31], a[108:111], a[44:47], v[28:31]
    v_cvt_pk_bf16_f32 v44, v20, v21
    v_cvt_pk_bf16_f32 v227, v118, v119
    ds_write_b128 v6, v[224:227] offset:12288
    s_waitcnt vmcnt(18)
    v_lshlrev_b32 v116, 16, v228
    v_and_b32 v117, s34, v228
    v_mul_f32 v116, s28, v116
    v_mul_f32 v117, s28, v117
    v_mfma_f32_16x16x32_bf16 v[32:35], a[112:115], a[32:35], 0
    v_exp_f32 v22, v22
    v_mfma_f32_16x16x32_bf16 v[32:35], a[116:119], a[36:39], v[32:35]
    v_cvt_pk_bf16_f32 v228, v116, v117
    v_lshlrev_b32 v118, 16, v229
    v_and_b32 v119, s34, v229
    v_mul_f32 v118, s28, v118
    v_mul_f32 v119, s28, v119
    v_cvt_pk_bf16_f32 v229, v118, v119
    v_lshlrev_b32 v116, 16, v230
    v_and_b32 v117, s34, v230
    v_mul_f32 v116, s28, v116
    v_mfma_f32_16x16x32_bf16 v[32:35], a[120:123], a[40:43], v[32:35]
    v_exp_f32 v23, v23
    v_mfma_f32_16x16x32_bf16 v[32:35], a[124:127], a[44:47], v[32:35]
    v_cvt_pk_bf16_f32 v45, v22, v23
    v_mul_f32 v117, s28, v117
    v_cvt_pk_bf16_f32 v230, v116, v117
    v_lshlrev_b32 v118, 16, v231
    v_and_b32 v119, s34, v231
    v_mul_f32 v118, s28, v118
    v_mul_f32 v119, s28, v119
    v_cvt_pk_bf16_f32 v231, v118, v119
    ds_write_b128 v6, v[228:231] offset:13312
    v_mfma_f32_16x16x32_bf16 v[160:163], a[128:131], v[36:39], 0
    v_exp_f32 v24, v24
    v_mfma_f32_16x16x32_bf16 v[160:163], a[132:135], v[40:43], v[160:163]
    s_waitcnt vmcnt(17)
    v_lshlrev_b32 v116, 16, v232
    v_and_b32 v117, s34, v232
    v_mul_f32 v116, s28, v116
    v_mul_f32 v117, s28, v117
    v_cvt_pk_bf16_f32 v232, v116, v117
    v_lshlrev_b32 v118, 16, v233
    v_and_b32 v119, s34, v233
    v_mfma_f32_16x16x32_bf16 v[164:167], a[136:139], v[36:39], 0
    v_exp_f32 v25, v25
    v_mfma_f32_16x16x32_bf16 v[164:167], a[140:143], v[40:43], v[164:167]
    v_cvt_pk_bf16_f32 v46, v24, v25
    v_mul_f32 v118, s28, v118
    v_mul_f32 v119, s28, v119
    v_cvt_pk_bf16_f32 v233, v118, v119
    v_lshlrev_b32 v116, 16, v234
    v_and_b32 v117, s34, v234
    v_mul_f32 v116, s28, v116
    v_mul_f32 v117, s28, v117
    v_cvt_pk_bf16_f32 v234, v116, v117
    v_mfma_f32_16x16x32_bf16 v[168:171], a[144:147], v[36:39], 0
    v_exp_f32 v26, v26
    v_mfma_f32_16x16x32_bf16 v[168:171], a[148:151], v[40:43], v[168:171]
    v_lshlrev_b32 v118, 16, v235
    v_and_b32 v119, s34, v235
    v_mul_f32 v118, s28, v118
    v_mul_f32 v119, s28, v119
    v_cvt_pk_bf16_f32 v235, v118, v119
    ds_write_b128 v6, v[232:235] offset:14336
    s_waitcnt vmcnt(16)
    v_lshlrev_b32 v116, 16, v236
    v_mfma_f32_16x16x32_bf16 v[172:175], a[152:155], v[36:39], 0
    v_exp_f32 v27, v27
    v_mfma_f32_16x16x32_bf16 v[172:175], a[156:159], v[40:43], v[172:175]
    v_cvt_pk_bf16_f32 v47, v26, v27
    v_and_b32 v117, s34, v236
    v_mul_f32 v116, s28, v116
    v_mul_f32 v117, s28, v117
    v_cvt_pk_bf16_f32 v236, v116, v117
    v_lshlrev_b32 v118, 16, v237
    v_and_b32 v119, s34, v237
    v_mul_f32 v118, s28, v118
    v_mul_f32 v119, s28, v119
    v_mfma_f32_16x16x32_bf16 v[176:179], a[160:163], v[36:39], 0
    v_exp_f32 v28, v28
    v_mfma_f32_16x16x32_bf16 v[176:179], a[164:167], v[40:43], v[176:179]
    v_cvt_pk_bf16_f32 v237, v118, v119
    v_lshlrev_b32 v116, 16, v238
    v_and_b32 v117, s34, v238
    v_mul_f32 v116, s28, v116
    v_mul_f32 v117, s28, v117
    v_cvt_pk_bf16_f32 v238, v116, v117
    v_lshlrev_b32 v118, 16, v239
    v_and_b32 v119, s34, v239
    v_mfma_f32_16x16x32_bf16 v[180:183], a[168:171], v[36:39], 0
    v_exp_f32 v29, v29
    v_mfma_f32_16x16x32_bf16 v[180:183], a[172:175], v[40:43], v[180:183]
    v_cvt_pk_bf16_f32 v48, v28, v29
    v_mul_f32 v118, s28, v118
    v_mul_f32 v119, s28, v119
    v_cvt_pk_bf16_f32 v239, v118, v119
    ds_write_b128 v6, v[236:239] offset:15360
    ds_read_b128 a[48:51], v5 offset:12288
    ds_read_b128 a[52:55], v5 offset:12544
    ds_read_b128 a[56:59], v5 offset:12800
    ds_read_b128 a[60:63], v5 offset:13056
    v_mfma_f32_16x16x32_bf16 v[184:187], a[176:179], v[36:39], 0
    v_exp_f32 v30, v30
    v_mfma_f32_16x16x32_bf16 v[184:187], a[180:183], v[40:43], v[184:187]
    v_mfma_f32_16x16x32_bf16 v[188:191], a[184:187], v[36:39], 0
    v_exp_f32 v31, v31
    v_mfma_f32_16x16x32_bf16 v[188:191], a[188:191], v[40:43], v[188:191]
    v_cvt_pk_bf16_f32 v49, v30, v31
    v_smfmac_f32_16x16x64_bf16 v[56:59], v[16:19], v[36:43], v14
    s_waitcnt lgkmcnt(0)
    v_mfma_f32_16x16x32_bf16 v[20:23], a[64:67], a[48:51], 0
    v_exp_f32 v32, v32
    v_mfma_f32_16x16x32_bf16 v[20:23], a[68:71], a[52:55], v[20:23]
    s_cmp_eq_u32 s30, s31
    s_cselect_b32 s32, 0xffff8000, s38
    v_mfma_f32_16x16x32_bf16 v[20:23], a[72:75], a[56:59], v[20:23]
    v_exp_f32 v33, v33
    v_mfma_f32_16x16x32_bf16 v[20:23], a[76:79], a[60:63], v[20:23]
    v_cvt_pk_bf16_f32 v50, v32, v33
    v_add_u32 v3, s32, v3
    v_mfma_f32_16x16x32_bf16 v[24:27], a[80:83], a[48:51], 0
    v_exp_f32 v34, v34
    v_mfma_f32_16x16x32_bf16 v[24:27], a[84:87], a[52:55], v[24:27]
    v_add_u32 v4, s32, v4
    v_add_u32 v2, s32, v2
    v_mfma_f32_16x16x32_bf16 v[24:27], a[88:91], a[56:59], v[24:27]
    v_exp_f32 v35, v35
    v_mfma_f32_16x16x32_bf16 v[24:27], a[92:95], a[60:63], v[24:27]
    v_cvt_pk_bf16_f32 v51, v34, v35
    v_mfma_f32_16x16x32_bf16 v[28:31], a[96:99], a[48:51], 0
    v_exp_f32 v20, v20
    v_mfma_f32_16x16x32_bf16 v[28:31], a[100:103], a[52:55], v[28:31]
    s_waitcnt vmcnt(12)
    s_barrier
    v_mfma_f32_16x16x32_bf16 v[28:31], a[104:107], a[56:59], v[28:31]
    v_exp_f32 v21, v21
    v_mfma_f32_16x16x32_bf16 v[28:31], a[108:111], a[60:63], v[28:31]
    ds_read_b128 a[64:67], v2 offset:0
    v_cvt_pk_bf16_f32 v36, v20, v21
    s_add_u32 s36, s36, 114688
    buffer_load_dwordx4 v[68:71], v1, s[12:15], s36 offen offset:0 nt
    v_mfma_f32_16x16x32_bf16 v[32:35], a[112:115], a[48:51], 0
    v_exp_f32 v22, v22
    v_mfma_f32_16x16x32_bf16 v[32:35], a[116:119], a[52:55], v[32:35]
    ds_read_b128 a[68:71], v2 offset:256
    ds_read_b128 a[72:75], v2 offset:512
    ds_read_b128 a[76:79], v2 offset:768
    v_xor_b32 v1, 48, v1
    buffer_load_dwordx4 v[72:75], v1, s[12:15], s36 offen offset:1024 nt
    v_mfma_f32_16x16x32_bf16 v[32:35], a[120:123], a[56:59], v[32:35]
    v_exp_f32 v23, v23
    v_mfma_f32_16x16x32_bf16 v[32:35], a[124:127], a[60:63], v[32:35]
    ds_read_b128 a[80:83], v2 offset:4096
    v_cvt_pk_bf16_f32 v37, v22, v23
    v_xor_b32 v1, 16, v1
    s_add_u32 s36, s36, 2048
    v_mfma_f32_16x16x32_bf16 v[192:195], a[128:131], v[44:47], 0
    v_exp_f32 v24, v24
    v_mfma_f32_16x16x32_bf16 v[192:195], a[132:135], v[48:51], v[192:195]
    ds_read_b128 a[84:87], v2 offset:4352
    ds_read_b128 a[88:91], v2 offset:4608
    v_mfma_f32_16x16x32_bf16 v[196:199], a[136:139], v[44:47], 0
    v_exp_f32 v25, v25
    v_mfma_f32_16x16x32_bf16 v[196:199], a[140:143], v[48:51], v[196:199]
    ds_read_b128 a[92:95], v2 offset:4864
    ds_read_b128 a[96:99], v2 offset:8192
    v_cvt_pk_bf16_f32 v38, v24, v25
    v_mfma_f32_16x16x32_bf16 v[200:203], a[144:147], v[44:47], 0
    v_exp_f32 v26, v26
    v_mfma_f32_16x16x32_bf16 v[200:203], a[148:151], v[48:51], v[200:203]
    ds_read_b128 a[100:103], v2 offset:8448
    ds_read_b128 a[104:107], v2 offset:8704
    v_mfma_f32_16x16x32_bf16 v[204:207], a[152:155], v[44:47], 0
    v_exp_f32 v27, v27
    v_mfma_f32_16x16x32_bf16 v[204:207], a[156:159], v[48:51], v[204:207]
    ds_read_b128 a[108:111], v2 offset:8960
    v_cvt_pk_bf16_f32 v39, v26, v27
    v_mfma_f32_16x16x32_bf16 v[208:211], a[160:163], v[44:47], 0
    v_exp_f32 v28, v28
    v_mfma_f32_16x16x32_bf16 v[208:211], a[164:167], v[48:51], v[208:211]
    ds_read_b128 a[112:115], v2 offset:12288
    ds_read_b128 a[116:119], v2 offset:12544
    ds_read_b128 a[120:123], v2 offset:12800
    v_mfma_f32_16x16x32_bf16 v[212:215], a[168:171], v[44:47], 0
    v_exp_f32 v29, v29
    v_mfma_f32_16x16x32_bf16 v[212:215], a[172:175], v[48:51], v[212:215]
    ds_read_b128 a[124:127], v2 offset:13056
    v_cvt_pk_bf16_f32 v40, v28, v29
    v_mfma_f32_16x16x32_bf16 v[216:219], a[176:179], v[44:47], 0
    v_exp_f32 v30, v30
    v_mfma_f32_16x16x32_bf16 v[216:219], a[180:183], v[48:51], v[216:219]
    v_mfma_f32_16x16x32_bf16 v[220:223], a[184:187], v[44:47], 0
    v_exp_f32 v31, v31
    v_mfma_f32_16x16x32_bf16 v[220:223], a[188:191], v[48:51], v[220:223]
    v_cvt_pk_bf16_f32 v41, v30, v31
    v_smfmac_f32_16x16x64_bf16 v[60:63], v[16:19], v[44:51], v14
    s_waitcnt lgkmcnt(0)
    v_mfma_f32_16x16x32_bf16 v[20:23], a[64:67], a[0:3], 0
    v_exp_f32 v32, v32
    v_mfma_f32_16x16x32_bf16 v[20:23], a[68:71], a[4:7], v[20:23]
    v_mfma_f32_16x16x32_bf16 v[20:23], a[72:75], a[8:11], v[20:23]
    v_exp_f32 v33, v33
    v_mfma_f32_16x16x32_bf16 v[20:23], a[76:79], a[12:15], v[20:23]
    v_cvt_pk_bf16_f32 v42, v32, v33
    v_mfma_f32_16x16x32_bf16 v[24:27], a[80:83], a[0:3], 0
    v_exp_f32 v34, v34
    v_mfma_f32_16x16x32_bf16 v[24:27], a[84:87], a[4:7], v[24:27]
    s_waitcnt vmcnt(10)
    s_barrier
    v_mfma_f32_16x16x32_bf16 v[24:27], a[88:91], a[8:11], v[24:27]
    v_exp_f32 v35, v35
    v_mfma_f32_16x16x32_bf16 v[24:27], a[92:95], a[12:15], v[24:27]
    ds_read_b64_tr_b16 a[192:193], v3 offset:0
    ds_read_b64_tr_b16 a[194:195], v3 offset:4096
    v_cvt_pk_bf16_f32 v43, v34, v35
    s_mov_b32 m0, s30
    v_mfma_f32_16x16x32_bf16 v[28:31], a[96:99], a[0:3], 0
    v_exp_f32 v20, v20
    v_mfma_f32_16x16x32_bf16 v[28:31], a[100:103], a[4:7], v[28:31]
    ds_read_b64_tr_b16 a[196:197], v3 offset:8192
    ds_read_b64_tr_b16 a[198:199], v3 offset:12288
    ds_read_b64_tr_b16 a[200:201], v4 offset:0
    ds_read_b64_tr_b16 a[202:203], v4 offset:4096
    buffer_load_dwordx4 v10, s[16:19], s29 offen offset:0 nt lds
    v_mfma_f32_16x16x32_bf16 v[28:31], a[104:107], a[8:11], v[28:31]
    v_exp_f32 v21, v21
    v_mfma_f32_16x16x32_bf16 v[28:31], a[108:111], a[12:15], v[28:31]
    ds_read_b64_tr_b16 a[204:205], v4 offset:8192
    ds_read_b64_tr_b16 a[206:207], v4 offset:12288
    v_cvt_pk_bf16_f32 v44, v20, v21
    buffer_load_dwordx4 v11, s[16:19], s29 offen offset:1024 nt lds
    v_mfma_f32_16x16x32_bf16 v[32:35], a[112:115], a[0:3], 0
    v_exp_f32 v22, v22
    v_mfma_f32_16x16x32_bf16 v[32:35], a[116:119], a[4:7], v[32:35]
    ds_read_b64_tr_b16 a[208:209], v3 offset:256
    ds_read_b64_tr_b16 a[210:211], v3 offset:4352
    ds_read_b64_tr_b16 a[212:213], v3 offset:8448
    ds_read_b64_tr_b16 a[214:215], v3 offset:12544
    v_mfma_f32_16x16x32_bf16 v[32:35], a[120:123], a[8:11], v[32:35]
    v_exp_f32 v23, v23
    v_mfma_f32_16x16x32_bf16 v[32:35], a[124:127], a[12:15], v[32:35]
    ds_read_b64_tr_b16 a[216:217], v4 offset:256
    ds_read_b64_tr_b16 a[218:219], v4 offset:4352
    v_cvt_pk_bf16_f32 v45, v22, v23
    buffer_load_dwordx4 v12, s[16:19], s29 offen offset:2048 nt lds
    v_mfma_f32_16x16x32_bf16 v[224:227], a[128:131], v[36:39], 0
    v_exp_f32 v24, v24
    v_mfma_f32_16x16x32_bf16 v[224:227], a[132:135], v[40:43], v[224:227]
    ds_read_b64_tr_b16 a[220:221], v4 offset:8448
    ds_read_b64_tr_b16 a[222:223], v4 offset:12544
    ds_read_b64_tr_b16 a[224:225], v3 offset:512
    ds_read_b64_tr_b16 a[226:227], v3 offset:4608
    buffer_load_dwordx4 v13, s[16:19], s29 offen offset:3072 nt lds
    v_mfma_f32_16x16x32_bf16 v[228:231], a[136:139], v[36:39], 0
    v_exp_f32 v25, v25
    v_mfma_f32_16x16x32_bf16 v[228:231], a[140:143], v[40:43], v[228:231]
    ds_read_b64_tr_b16 a[228:229], v3 offset:8704
    ds_read_b64_tr_b16 a[230:231], v3 offset:12800
    v_cvt_pk_bf16_f32 v46, v24, v25
    v_mfma_f32_16x16x32_bf16 v[232:235], a[144:147], v[36:39], 0
    v_exp_f32 v26, v26
    v_mfma_f32_16x16x32_bf16 v[232:235], a[148:151], v[40:43], v[232:235]
    ds_read_b64_tr_b16 a[232:233], v4 offset:512
    ds_read_b64_tr_b16 a[234:235], v4 offset:4608
    ds_read_b64_tr_b16 a[236:237], v4 offset:8704
    ds_read_b64_tr_b16 a[238:239], v4 offset:12800
    s_add_u32 m0, s30, 49152
    v_mfma_f32_16x16x32_bf16 v[236:239], a[152:155], v[36:39], 0
    v_exp_f32 v27, v27
    v_mfma_f32_16x16x32_bf16 v[236:239], a[156:159], v[40:43], v[236:239]
    ds_read_b64_tr_b16 a[240:241], v3 offset:768
    ds_read_b64_tr_b16 a[242:243], v3 offset:4864
    v_cvt_pk_bf16_f32 v47, v26, v27
    buffer_load_dwordx4 v10, s[20:23], s29 offen offset:0 nt lds
    v_mfma_f32_16x16x32_bf16 v[240:243], a[160:163], v[36:39], 0
    v_exp_f32 v28, v28
    v_mfma_f32_16x16x32_bf16 v[240:243], a[164:167], v[40:43], v[240:243]
    ds_read_b64_tr_b16 a[244:245], v3 offset:8960
    ds_read_b64_tr_b16 a[246:247], v3 offset:13056
    ds_read_b64_tr_b16 a[248:249], v4 offset:768
    ds_read_b64_tr_b16 a[250:251], v4 offset:4864
    buffer_load_dwordx4 v11, s[20:23], s29 offen offset:1024 nt lds
    v_mfma_f32_16x16x32_bf16 v[244:247], a[168:171], v[36:39], 0
    v_exp_f32 v29, v29
    v_mfma_f32_16x16x32_bf16 v[244:247], a[172:175], v[40:43], v[244:247]
    ds_read_b64_tr_b16 a[252:253], v4 offset:8960
    ds_read_b64_tr_b16 a[254:255], v4 offset:13056
    v_cvt_pk_bf16_f32 v48, v28, v29
    v_mfma_f32_16x16x32_bf16 v[248:251], a[176:179], v[36:39], 0
    v_exp_f32 v30, v30
    v_mfma_f32_16x16x32_bf16 v[248:251], a[180:183], v[40:43], v[248:251]
    buffer_load_dwordx4 v12, s[20:23], s29 offen offset:2048 nt lds
    buffer_load_dwordx4 v13, s[20:23], s29 offen offset:3072 nt lds
    v_mfma_f32_16x16x32_bf16 v[252:255], a[184:187], v[36:39], 0
    v_exp_f32 v31, v31
    v_mfma_f32_16x16x32_bf16 v[252:255], a[188:191], v[40:43], v[252:255]
    v_cvt_pk_bf16_f32 v49, v30, v31
    s_add_u32 s29, s29, 16384
    s_add_u32 s30, s30, s32
    v_smfmac_f32_16x16x64_bf16 v[64:67], v[16:19], v[36:43], v14
    s_cmp_eq_u32 s30, s31
    s_cselect_b32 s32, 0xffff8000, s38
    v_add_u32 v3, s32, v3
    v_add_u32 v4, s32, v4
    v_add_u32 v2, s32, v2
LOOPQ:
    v_mfma_f32_16x16x32_bf16 v[20:23], a[64:67], a[16:19], 0
    v_exp_f32 v32, v32
    v_mfma_f32_16x16x32_bf16 v[20:23], a[68:71], a[20:23], v[20:23]
    s_waitcnt vmcnt(10) lgkmcnt(0)
    s_barrier
    v_mfma_f32_16x16x32_bf16 v[20:23], a[72:75], a[24:27], v[20:23]
    v_exp_f32 v33, v33
    v_mfma_f32_16x16x32_bf16 v[20:23], a[76:79], a[28:31], v[20:23]
    v_cvt_pk_bf16_f32 v50, v32, v33
    s_mov_b32 m0, s30
    v_mfma_f32_16x16x32_bf16 v[24:27], a[80:83], a[16:19], 0
    v_exp_f32 v34, v34
    v_mfma_f32_16x16x32_bf16 v[24:27], a[84:87], a[20:23], v[24:27]
    buffer_load_dwordx4 v10, s[16:19], s29 offen offset:0 nt lds
    v_mfma_f32_16x16x32_bf16 v[24:27], a[88:91], a[24:27], v[24:27]
    v_exp_f32 v35, v35
    v_mfma_f32_16x16x32_bf16 v[24:27], a[92:95], a[28:31], v[24:27]
    ds_read_b64_tr_b16 a[128:129], v3 offset:0
    v_cvt_pk_bf16_f32 v51, v34, v35
    v_mfma_f32_16x16x32_bf16 v[28:31], a[96:99], a[16:19], 0
    v_exp_f32 v20, v20
    v_mfma_f32_16x16x32_bf16 v[28:31], a[100:103], a[20:23], v[28:31]
    ds_read_b64_tr_b16 a[130:131], v3 offset:4096
    s_waitcnt vmcnt(10)
    v_mfma_f32_16x16x32_bf16 v[28:31], a[104:107], a[24:27], v[28:31]
    v_exp_f32 v21, v21
    v_mfma_f32_16x16x32_bf16 v[28:31], a[108:111], a[28:31], v[28:31]
    ds_read_b64_tr_b16 a[132:133], v3 offset:8192
    v_cvt_pk_bf16_f32 v36, v20, v21
    v_mfma_f32_16x16x32_bf16 v[32:35], a[112:115], a[16:19], 0
    v_exp_f32 v22, v22
    v_mfma_f32_16x16x32_bf16 v[32:35], a[116:119], a[20:23], v[32:35]
    buffer_load_dwordx4 v11, s[16:19], s29 offen offset:1024 nt lds
    v_mfma_f32_16x16x32_bf16 v[32:35], a[120:123], a[24:27], v[32:35]
    v_exp_f32 v23, v23
    v_mfma_f32_16x16x32_bf16 v[32:35], a[124:127], a[28:31], v[32:35]
    ds_read_b64_tr_b16 a[134:135], v3 offset:12288
    v_cvt_pk_bf16_f32 v37, v22, v23
    v_mfma_f32_16x16x32_bf16 v[128:131], a[192:195], v[44:47], v[128:131]
    v_exp_f32 v24, v24
    v_mfma_f32_16x16x32_bf16 v[128:131], a[196:199], v[48:51], v[128:131]
    ds_read_b64_tr_b16 a[136:137], v4 offset:0
    v_lshlrev_b32 v116, 16, v68
    v_mfma_f32_16x16x32_bf16 v[132:135], a[200:203], v[44:47], v[132:135]
    v_exp_f32 v25, v25
    v_mfma_f32_16x16x32_bf16 v[132:135], a[204:207], v[48:51], v[132:135]
    ds_read_b64_tr_b16 a[138:139], v4 offset:4096
    v_cvt_pk_bf16_f32 v38, v24, v25
    v_mfma_f32_16x16x32_bf16 v[136:139], a[208:211], v[44:47], v[136:139]
    v_exp_f32 v26, v26
    v_mfma_f32_16x16x32_bf16 v[136:139], a[212:215], v[48:51], v[136:139]
    buffer_load_dwordx4 v12, s[16:19], s29 offen offset:2048 nt lds
    v_mfma_f32_16x16x32_bf16 v[140:143], a[216:219], v[44:47], v[140:143]
    v_exp_f32 v27, v27
    v_mfma_f32_16x16x32_bf16 v[140:143], a[220:223], v[48:51], v[140:143]
    ds_read_b64_tr_b16 a[140:141], v4 offset:8192
    v_cvt_pk_bf16_f32 v39, v26, v27
    v_mfma_f32_16x16x32_bf16 v[144:147], a[224:227], v[44:47], v[144:147]
    v_exp_f32 v28, v28
    v_mfma_f32_16x16x32_bf16 v[144:147], a[228:231], v[48:51], v[144:147]
    ds_read_b64_tr_b16 a[142:143], v4 offset:12288
    v_and_b32 v117, s34, v68
    v_mfma_f32_16x16x32_bf16 v[148:151], a[232:235], v[44:47], v[148:151]
    v_exp_f32 v29, v29
    v_mfma_f32_16x16x32_bf16 v[148:151], a[236:239], v[48:51], v[148:151]
    ds_read_b64_tr_b16 a[144:145], v3 offset:256
    v_cvt_pk_bf16_f32 v40, v28, v29
    v_mfma_f32_16x16x32_bf16 v[152:155], a[240:243], v[44:47], v[152:155]
    v_exp_f32 v30, v30
    v_mfma_f32_16x16x32_bf16 v[152:155], a[244:247], v[48:51], v[152:155]
    buffer_load_dwordx4 v13, s[16:19], s29 offen offset:3072 nt lds
    v_mfma_f32_16x16x32_bf16 v[156:159], a[248:251], v[44:47], v[156:159]
    v_exp_f32 v31, v31
    v_mfma_f32_16x16x32_bf16 v[156:159], a[252:255], v[48:51], v[156:159]
    ds_read_b64_tr_b16 a[146:147], v3 offset:4352
    v_cvt_pk_bf16_f32 v41, v30, v31
    v_smfmac_f32_16x16x64_bf16 v[52:55], v[16:19], v[44:51], v14
    ds_read_b64_tr_b16 a[148:149], v3 offset:8448
    v_mul_f32 v116, s28, v116
    v_mfma_f32_16x16x32_bf16 v[20:23], a[64:67], a[32:35], 0
    v_exp_f32 v32, v32
    v_mfma_f32_16x16x32_bf16 v[20:23], a[68:71], a[36:39], v[20:23]
    ds_read_b64_tr_b16 a[150:151], v3 offset:12544
    v_mul_f32 v117, s28, v117
    v_mfma_f32_16x16x32_bf16 v[20:23], a[72:75], a[40:43], v[20:23]
    v_exp_f32 v33, v33
PG1:
    s_cbranch_vccnz PG5
    v_mfma_f32_16x16x32_bf16 v[20:23], a[76:79], a[44:47], v[20:23]
    v_cvt_pk_bf16_f32 v42, v32, v33
    s_add_u32 m0, s30, 49152
    v_mfma_f32_16x16x32_bf16 v[24:27], a[80:83], a[32:35], 0
    v_exp_f32 v34, v34
    v_mfma_f32_16x16x32_bf16 v[24:27], a[84:87], a[36:39], v[24:27]
    buffer_load_dwordx4 v10, s[20:23], s29 offen offset:0 nt lds
    v_mfma_f32_16x16x32_bf16 v[24:27], a[88:91], a[40:43], v[24:27]
    v_exp_f32 v35, v35
    v_mfma_f32_16x16x32_bf16 v[24:27], a[92:95], a[44:47], v[24:27]
    ds_read_b64_tr_b16 a[152:153], v4 offset:256
    v_cvt_pk_bf16_f32 v43, v34, v35
    v_mfma_f32_16x16x32_bf16 v[28:31], a[96:99], a[32:35], 0
    v_exp_f32 v20, v20
    v_mfma_f32_16x16x32_bf16 v[28:31], a[100:103], a[36:39], v[28:31]
    ds_read_b64_tr_b16 a[154:155], v4 offset:4352
    v_cvt_pk_bf16_f32 v68, v116, v117
    v_mfma_f32_16x16x32_bf16 v[28:31], a[104:107], a[40:43], v[28:31]
    v_exp_f32 v21, v21
    v_mfma_f32_16x16x32_bf16 v[28:31], a[108:111], a[44:47], v[28:31]
    ds_read_b64_tr_b16 a[156:157], v4 offset:8448
    v_cvt_pk_bf16_f32 v44, v20, v21
    v_mfma_f32_16x16x32_bf16 v[32:35], a[112:115], a[32:35], 0
    v_exp_f32 v22, v22
    v_mfma_f32_16x16x32_bf16 v[32:35], a[116:119], a[36:39], v[32:35]
    buffer_load_dwordx4 v11, s[20:23], s29 offen offset:1024 nt lds
    v_mfma_f32_16x16x32_bf16 v[32:35], a[120:123], a[40:43], v[32:35]
    v_exp_f32 v23, v23
    v_mfma_f32_16x16x32_bf16 v[32:35], a[124:127], a[44:47], v[32:35]
    ds_read_b64_tr_b16 a[158:159], v4 offset:12544
    v_cvt_pk_bf16_f32 v45, v22, v23
    v_mfma_f32_16x16x32_bf16 v[160:163], a[192:195], v[36:39], v[160:163]
    v_exp_f32 v24, v24
    v_mfma_f32_16x16x32_bf16 v[160:163], a[196:199], v[40:43], v[160:163]
    ds_read_b64_tr_b16 a[160:161], v3 offset:512
    v_lshlrev_b32 v118, 16, v69
    v_mfma_f32_16x16x32_bf16 v[164:167], a[200:203], v[36:39], v[164:167]
    v_exp_f32 v25, v25
    v_mfma_f32_16x16x32_bf16 v[164:167], a[204:207], v[40:43], v[164:167]
    ds_read_b64_tr_b16 a[162:163], v3 offset:4608
    v_cvt_pk_bf16_f32 v46, v24, v25
    v_mfma_f32_16x16x32_bf16 v[168:171], a[208:211], v[36:39], v[168:171]
    v_exp_f32 v26, v26
    v_mfma_f32_16x16x32_bf16 v[168:171], a[212:215], v[40:43], v[168:171]
    buffer_load_dwordx4 v12, s[20:23], s29 offen offset:2048 nt lds
    v_mfma_f32_16x16x32_bf16 v[172:175], a[216:219], v[36:39], v[172:175]
    v_exp_f32 v27, v27
    v_mfma_f32_16x16x32_bf16 v[172:175], a[220:223], v[40:43], v[172:175]
    ds_read_b64_tr_b16 a[164:165], v3 offset:8704
    v_cvt_pk_bf16_f32 v47, v26, v27
    v_mfma_f32_16x16x32_bf16 v[176:179], a[224:227], v[36:39], v[176:179]
    v_exp_f32 v28, v28
    v_mfma_f32_16x16x32_bf16 v[176:179], a[228:231], v[40:43], v[176:179]
    ds_read_b64_tr_b16 a[166:167], v3 offset:12800
    v_and_b32 v119, s34, v69
    v_mfma_f32_16x16x32_bf16 v[180:183], a[232:235], v[36:39], v[180:183]
    v_exp_f32 v29, v29
    v_mfma_f32_16x16x32_bf16 v[180:183], a[236:239], v[40:43], v[180:183]
    ds_read_b64_tr_b16 a[168:169], v4 offset:512
    v_cvt_pk_bf16_f32 v48, v28, v29
    v_mfma_f32_16x16x32_bf16 v[184:187], a[240:243], v[36:39], v[184:187]
    v_exp_f32 v30, v30
    v_mfma_f32_16x16x32_bf16 v[184:187], a[244:247], v[40:43], v[184:187]
    buffer_load_dwordx4 v13, s[20:23], s29 offen offset:3072 nt lds
    v_mfma_f32_16x16x32_bf16 v[188:191], a[248:251], v[36:39], v[188:191]
    v_exp_f32 v31, v31
    v_mfma_f32_16x16x32_bf16 v[188:191], a[252:255], v[40:43], v[188:191]
    ds_read_b64_tr_b16 a[170:171], v4 offset:4608
    v_cvt_pk_bf16_f32 v49, v30, v31
    v_smfmac_f32_16x16x64_bf16 v[56:59], v[16:19], v[36:43], v14
    ds_read_b64_tr_b16 a[172:173], v4 offset:8704
    s_add_u32 s29, s29, 16384
    v_mfma_f32_16x16x32_bf16 v[20:23], a[64:67], a[48:51], 0
    v_exp_f32 v32, v32
    v_mfma_f32_16x16x32_bf16 v[20:23], a[68:71], a[52:55], v[20:23]
    ds_read_b128 a[64:67], v2 offset:0
    ds_read_b128 a[68:71], v2 offset:256
    v_mfma_f32_16x16x32_bf16 v[20:23], a[72:75], a[56:59], v[20:23]
    v_exp_f32 v33, v33
    v_mfma_f32_16x16x32_bf16 v[20:23], a[76:79], a[60:63], v[20:23]
    ds_read_b128 a[72:75], v2 offset:512
    v_cvt_pk_bf16_f32 v50, v32, v33
    v_mfma_f32_16x16x32_bf16 v[24:27], a[80:83], a[48:51], 0
    v_exp_f32 v34, v34
    v_mfma_f32_16x16x32_bf16 v[24:27], a[84:87], a[52:55], v[24:27]
    ds_read_b128 a[76:79], v2 offset:768
    s_add_u32 s30, s30, s32
    v_mfma_f32_16x16x32_bf16 v[24:27], a[88:91], a[56:59], v[24:27]
    v_exp_f32 v35, v35
    v_mfma_f32_16x16x32_bf16 v[24:27], a[92:95], a[60:63], v[24:27]
    ds_read_b128 a[80:83], v2 offset:4096
    v_cvt_pk_bf16_f32 v51, v34, v35
    v_mfma_f32_16x16x32_bf16 v[28:31], a[96:99], a[48:51], 0
    v_exp_f32 v20, v20
    v_mfma_f32_16x16x32_bf16 v[28:31], a[100:103], a[52:55], v[28:31]
    ds_read_b128 a[84:87], v2 offset:4352
    v_mul_f32 v118, s28, v118
    v_mfma_f32_16x16x32_bf16 v[28:31], a[104:107], a[56:59], v[28:31]
    v_exp_f32 v21, v21
    v_mfma_f32_16x16x32_bf16 v[28:31], a[108:111], a[60:63], v[28:31]
    ds_read_b128 a[88:91], v2 offset:4608
    v_cvt_pk_bf16_f32 v36, v20, v21
    v_mfma_f32_16x16x32_bf16 v[32:35], a[112:115], a[48:51], 0
    v_exp_f32 v22, v22
    v_mfma_f32_16x16x32_bf16 v[32:35], a[116:119], a[52:55], v[32:35]
    ds_read_b128 a[92:95], v2 offset:4864
    v_mul_f32 v119, s28, v119
    v_mfma_f32_16x16x32_bf16 v[32:35], a[120:123], a[56:59], v[32:35]
    v_exp_f32 v23, v23
    v_mfma_f32_16x16x32_bf16 v[32:35], a[124:127], a[60:63], v[32:35]
    ds_read_b128 a[96:99], v2 offset:8192
    v_cvt_pk_bf16_f32 v37, v22, v23
    v_mfma_f32_16x16x32_bf16 v[192:195], a[192:195], v[44:47], v[192:195]
    v_exp_f32 v24, v24
    v_mfma_f32_16x16x32_bf16 v[192:195], a[196:199], v[48:51], v[192:195]
    ds_read_b128 a[100:103], v2 offset:8448
    v_cvt_pk_bf16_f32 v69, v118, v119
    v_mfma_f32_16x16x32_bf16 v[196:199], a[200:203], v[44:47], v[196:199]
    v_exp_f32 v25, v25
    v_mfma_f32_16x16x32_bf16 v[196:199], a[204:207], v[48:51], v[196:199]
    ds_read_b128 a[104:107], v2 offset:8704
    v_cvt_pk_bf16_f32 v38, v24, v25
    v_mfma_f32_16x16x32_bf16 v[200:203], a[208:211], v[44:47], v[200:203]
    v_exp_f32 v26, v26
    v_mfma_f32_16x16x32_bf16 v[200:203], a[212:215], v[48:51], v[200:203]
    ds_read_b128 a[108:111], v2 offset:8960
    v_lshlrev_b32 v116, 16, v70
    v_mfma_f32_16x16x32_bf16 v[204:207], a[216:219], v[44:47], v[204:207]
    v_exp_f32 v27, v27
    v_mfma_f32_16x16x32_bf16 v[204:207], a[220:223], v[48:51], v[204:207]
    ds_read_b128 a[112:115], v2 offset:12288
    v_cvt_pk_bf16_f32 v39, v26, v27
    v_mfma_f32_16x16x32_bf16 v[208:211], a[224:227], v[44:47], v[208:211]
    v_exp_f32 v28, v28
    v_mfma_f32_16x16x32_bf16 v[208:211], a[228:231], v[48:51], v[208:211]
    ds_read_b128 a[116:119], v2 offset:12544
    v_and_b32 v117, s34, v70
    v_mfma_f32_16x16x32_bf16 v[212:215], a[232:235], v[44:47], v[212:215]
    v_exp_f32 v29, v29
    v_mfma_f32_16x16x32_bf16 v[212:215], a[236:239], v[48:51], v[212:215]
    ds_read_b128 a[120:123], v2 offset:12800
    v_cvt_pk_bf16_f32 v40, v28, v29
    v_mfma_f32_16x16x32_bf16 v[216:219], a[240:243], v[44:47], v[216:219]
    v_exp_f32 v30, v30
    v_mfma_f32_16x16x32_bf16 v[216:219], a[244:247], v[48:51], v[216:219]
    ds_read_b128 a[124:127], v2 offset:13056
    v_mul_f32 v116, s28, v116
    v_mfma_f32_16x16x32_bf16 v[220:223], a[248:251], v[44:47], v[220:223]
    v_exp_f32 v31, v31
    v_mfma_f32_16x16x32_bf16 v[220:223], a[252:255], v[48:51], v[220:223]
    v_cvt_pk_bf16_f32 v41, v30, v31
    v_mul_f32 v117, s28, v117
    v_smfmac_f32_16x16x64_bf16 v[60:63], v[16:19], v[44:51], v14
    s_waitcnt lgkmcnt(4)
    v_cvt_pk_bf16_f32 v70, v116, v117
    v_mfma_f32_16x16x32_bf16 v[20:23], a[64:67], a[0:3], 0
    v_exp_f32 v32, v32
    v_mfma_f32_16x16x32_bf16 v[20:23], a[68:71], a[4:7], v[20:23]
    ds_read_b64_tr_b16 a[174:175], v4 offset:12800
    v_lshlrev_b32 v118, 16, v71
    v_mfma_f32_16x16x32_bf16 v[20:23], a[72:75], a[8:11], v[20:23]
    v_exp_f32 v33, v33
    v_mfma_f32_16x16x32_bf16 v[20:23], a[76:79], a[12:15], v[20:23]
    ds_read_b64_tr_b16 a[176:177], v3 offset:768
    v_cvt_pk_bf16_f32 v42, v32, v33
    v_mfma_f32_16x16x32_bf16 v[24:27], a[80:83], a[0:3], 0
    v_exp_f32 v34, v34
    v_mfma_f32_16x16x32_bf16 v[24:27], a[84:87], a[4:7], v[24:27]
    ds_read_b64_tr_b16 a[178:179], v3 offset:4864
    v_and_b32 v119, s34, v71
    v_mfma_f32_16x16x32_bf16 v[24:27], a[88:91], a[8:11], v[24:27]
    v_exp_f32 v35, v35
    v_mfma_f32_16x16x32_bf16 v[24:27], a[92:95], a[12:15], v[24:27]
    ds_read_b64_tr_b16 a[180:181], v3 offset:8960
    v_cvt_pk_bf16_f32 v43, v34, v35
    v_mfma_f32_16x16x32_bf16 v[28:31], a[96:99], a[0:3], 0
    v_exp_f32 v20, v20
    v_mfma_f32_16x16x32_bf16 v[28:31], a[100:103], a[4:7], v[28:31]
    ds_read_b64_tr_b16 a[182:183], v3 offset:13056
    v_mul_f32 v118, s28, v118
    v_mfma_f32_16x16x32_bf16 v[28:31], a[104:107], a[8:11], v[28:31]
    v_exp_f32 v21, v21
    v_mfma_f32_16x16x32_bf16 v[28:31], a[108:111], a[12:15], v[28:31]
    v_cvt_pk_bf16_f32 v44, v20, v21
    s_waitcnt lgkmcnt(5)
    v_mfma_f32_16x16x32_bf16 v[32:35], a[112:115], a[0:3], 0
    v_exp_f32 v22, v22
    v_mfma_f32_16x16x32_bf16 v[32:35], a[116:119], a[4:7], v[32:35]
    ds_read_b64_tr_b16 a[184:185], v4 offset:768
    v_mul_f32 v119, s28, v119
    v_mfma_f32_16x16x32_bf16 v[32:35], a[120:123], a[8:11], v[32:35]
    v_exp_f32 v23, v23
    v_mfma_f32_16x16x32_bf16 v[32:35], a[124:127], a[12:15], v[32:35]
    ds_read_b64_tr_b16 a[186:187], v4 offset:4864
    v_cvt_pk_bf16_f32 v45, v22, v23
    v_mfma_f32_16x16x32_bf16 v[224:227], a[192:195], v[36:39], v[224:227]
    v_exp_f32 v24, v24
    v_mfma_f32_16x16x32_bf16 v[224:227], a[196:199], v[40:43], v[224:227]
    ds_read_b64_tr_b16 a[188:189], v4 offset:8960
    v_cvt_pk_bf16_f32 v71, v118, v119
    v_mfma_f32_16x16x32_bf16 v[228:231], a[200:203], v[36:39], v[228:231]
    v_exp_f32 v25, v25
    v_mfma_f32_16x16x32_bf16 v[228:231], a[204:207], v[40:43], v[228:231]
    ds_read_b64_tr_b16 a[190:191], v4 offset:13056
    v_cvt_pk_bf16_f32 v46, v24, v25
    v_mfma_f32_16x16x32_bf16 v[232:235], a[208:211], v[36:39], v[232:235]
    v_exp_f32 v26, v26
    v_mfma_f32_16x16x32_bf16 v[232:235], a[212:215], v[40:43], v[232:235]
    ds_write_b128 v15, v[68:71] offset:0
    v_mfma_f32_16x16x32_bf16 v[236:239], a[216:219], v[36:39], v[236:239]
    v_exp_f32 v27, v27
    v_mfma_f32_16x16x32_bf16 v[236:239], a[220:223], v[40:43], v[236:239]
    v_cvt_pk_bf16_f32 v47, v26, v27
    buffer_load_dwordx4 v[68:71], v1, s[12:15], s36 offen offset:0 nt
    v_mfma_f32_16x16x32_bf16 v[240:243], a[224:227], v[36:39], v[240:243]
    v_exp_f32 v28, v28
    v_mfma_f32_16x16x32_bf16 v[240:243], a[228:231], v[40:43], v[240:243]
    s_cmp_eq_u32 s30, s31
    s_cselect_b32 s32, 0xffff8000, s38
    v_mfma_f32_16x16x32_bf16 v[244:247], a[232:235], v[36:39], v[244:247]
    v_exp_f32 v29, v29
    v_mfma_f32_16x16x32_bf16 v[244:247], a[236:239], v[40:43], v[244:247]
    v_cvt_pk_bf16_f32 v48, v28, v29
    v_add_u32 v3, s32, v3
    v_mfma_f32_16x16x32_bf16 v[248:251], a[240:243], v[36:39], v[248:251]
    v_exp_f32 v30, v30
    v_mfma_f32_16x16x32_bf16 v[248:251], a[244:247], v[40:43], v[248:251]
    v_add_u32 v4, s32, v4
    v_add_u32 v2, s32, v2
    v_mfma_f32_16x16x32_bf16 v[252:255], a[248:251], v[36:39], v[252:255]
    v_exp_f32 v31, v31
    v_mfma_f32_16x16x32_bf16 v[252:255], a[252:255], v[40:43], v[252:255]
    v_cvt_pk_bf16_f32 v49, v30, v31
    v_xor_b32 v1, 48, v1
    v_smfmac_f32_16x16x64_bf16 v[64:67], v[16:19], v[36:43], v14
    v_mfma_f32_16x16x32_bf16 v[20:23], a[64:67], a[16:19], 0
    v_exp_f32 v32, v32
    v_mfma_f32_16x16x32_bf16 v[20:23], a[68:71], a[20:23], v[20:23]
    s_waitcnt vmcnt(9) lgkmcnt(1)
    s_barrier
    v_mfma_f32_16x16x32_bf16 v[20:23], a[72:75], a[24:27], v[20:23]
    v_exp_f32 v33, v33
    v_mfma_f32_16x16x32_bf16 v[20:23], a[76:79], a[28:31], v[20:23]
    v_cvt_pk_bf16_f32 v50, v32, v33
    s_mov_b32 m0, s30
    v_mfma_f32_16x16x32_bf16 v[24:27], a[80:83], a[16:19], 0
    v_exp_f32 v34, v34
    v_mfma_f32_16x16x32_bf16 v[24:27], a[84:87], a[20:23], v[24:27]
    buffer_load_dwordx4 v10, s[16:19], s29 offen offset:0 nt lds
    v_mfma_f32_16x16x32_bf16 v[24:27], a[88:91], a[24:27], v[24:27]
    v_exp_f32 v35, v35
    v_mfma_f32_16x16x32_bf16 v[24:27], a[92:95], a[28:31], v[24:27]
    ds_read_b64_tr_b16 a[192:193], v3 offset:0
    v_cvt_pk_bf16_f32 v51, v34, v35
    v_mfma_f32_16x16x32_bf16 v[28:31], a[96:99], a[16:19], 0
    v_exp_f32 v20, v20
    v_mfma_f32_16x16x32_bf16 v[28:31], a[100:103], a[20:23], v[28:31]
    ds_read_b64_tr_b16 a[194:195], v3 offset:4096
    s_waitcnt vmcnt(10)
    v_mfma_f32_16x16x32_bf16 v[28:31], a[104:107], a[24:27], v[28:31]
    v_exp_f32 v21, v21
    v_mfma_f32_16x16x32_bf16 v[28:31], a[108:111], a[28:31], v[28:31]
    ds_read_b64_tr_b16 a[196:197], v3 offset:8192
    v_cvt_pk_bf16_f32 v36, v20, v21
    v_mfma_f32_16x16x32_bf16 v[32:35], a[112:115], a[16:19], 0
    v_exp_f32 v22, v22
    v_mfma_f32_16x16x32_bf16 v[32:35], a[116:119], a[20:23], v[32:35]
    buffer_load_dwordx4 v11, s[16:19], s29 offen offset:1024 nt lds
    v_mfma_f32_16x16x32_bf16 v[32:35], a[120:123], a[24:27], v[32:35]
    v_exp_f32 v23, v23
    v_mfma_f32_16x16x32_bf16 v[32:35], a[124:127], a[28:31], v[32:35]
    ds_read_b64_tr_b16 a[198:199], v3 offset:12288
    v_cvt_pk_bf16_f32 v37, v22, v23
    v_mfma_f32_16x16x32_bf16 v[128:131], a[128:131], v[44:47], v[128:131]
    v_exp_f32 v24, v24
    v_mfma_f32_16x16x32_bf16 v[128:131], a[132:135], v[48:51], v[128:131]
    ds_read_b64_tr_b16 a[200:201], v4 offset:0
    v_lshlrev_b32 v116, 16, v72
    v_mfma_f32_16x16x32_bf16 v[132:135], a[136:139], v[44:47], v[132:135]
    v_exp_f32 v25, v25
    v_mfma_f32_16x16x32_bf16 v[132:135], a[140:143], v[48:51], v[132:135]
    ds_read_b64_tr_b16 a[202:203], v4 offset:4096
    v_cvt_pk_bf16_f32 v38, v24, v25
    v_mfma_f32_16x16x32_bf16 v[136:139], a[144:147], v[44:47], v[136:139]
    v_exp_f32 v26, v26
    v_mfma_f32_16x16x32_bf16 v[136:139], a[148:151], v[48:51], v[136:139]
    buffer_load_dwordx4 v12, s[16:19], s29 offen offset:2048 nt lds
    v_mfma_f32_16x16x32_bf16 v[140:143], a[152:155], v[44:47], v[140:143]
    v_exp_f32 v27, v27
    v_mfma_f32_16x16x32_bf16 v[140:143], a[156:159], v[48:51], v[140:143]
    ds_read_b64_tr_b16 a[204:205], v4 offset:8192
    v_cvt_pk_bf16_f32 v39, v26, v27
    v_mfma_f32_16x16x32_bf16 v[144:147], a[160:163], v[44:47], v[144:147]
    v_exp_f32 v28, v28
    v_mfma_f32_16x16x32_bf16 v[144:147], a[164:167], v[48:51], v[144:147]
    ds_read_b64_tr_b16 a[206:207], v4 offset:12288
    v_and_b32 v117, s34, v72
    v_mfma_f32_16x16x32_bf16 v[148:151], a[168:171], v[44:47], v[148:151]
    v_exp_f32 v29, v29
    v_mfma_f32_16x16x32_bf16 v[148:151], a[172:175], v[48:51], v[148:151]
    ds_read_b64_tr_b16 a[208:209], v3 offset:256
    v_cvt_pk_bf16_f32 v40, v28, v29
    v_mfma_f32_16x16x32_bf16 v[152:155], a[176:179], v[44:47], v[152:155]
    v_exp_f32 v30, v30
    v_mfma_f32_16x16x32_bf16 v[152:155], a[180:183], v[48:51], v[152:155]
    buffer_load_dwordx4 v13, s[16:19], s29 offen offset:3072 nt lds
    v_mfma_f32_16x16x32_bf16 v[156:159], a[184:187], v[44:47], v[156:159]
    v_exp_f32 v31, v31
    v_mfma_f32_16x16x32_bf16 v[156:159], a[188:191], v[48:51], v[156:159]
    ds_read_b64_tr_b16 a[210:211], v3 offset:4352
    v_cvt_pk_bf16_f32 v41, v30, v31
    v_smfmac_f32_16x16x64_bf16 v[52:55], v[16:19], v[44:51], v14
    ds_read_b64_tr_b16 a[212:213], v3 offset:8448
    v_mul_f32 v116, s28, v116
    v_mfma_f32_16x16x32_bf16 v[20:23], a[64:67], a[32:35], 0
    v_exp_f32 v32, v32
    v_mfma_f32_16x16x32_bf16 v[20:23], a[68:71], a[36:39], v[20:23]
    ds_read_b64_tr_b16 a[214:215], v3 offset:12544
    v_mul_f32 v117, s28, v117
    v_mfma_f32_16x16x32_bf16 v[20:23], a[72:75], a[40:43], v[20:23]
    v_exp_f32 v33, v33
    v_mfma_f32_16x16x32_bf16 v[20:23], a[76:79], a[44:47], v[20:23]
    v_cvt_pk_bf16_f32 v42, v32, v33
    s_add_u32 m0, s30, 49152
    v_mfma_f32_16x16x32_bf16 v[24:27], a[80:83], a[32:35], 0
    v_exp_f32 v34, v34
    v_mfma_f32_16x16x32_bf16 v[24:27], a[84:87], a[36:39], v[24:27]
    buffer_load_dwordx4 v10, s[20:23], s29 offen offset:0 nt lds
    v_mfma_f32_16x16x32_bf16 v[24:27], a[88:91], a[40:43], v[24:27]
    v_exp_f32 v35, v35
    v_mfma_f32_16x16x32_bf16 v[24:27], a[92:95], a[44:47], v[24:27]
    ds_read_b64_tr_b16 a[216:217], v4 offset:256
    v_cvt_pk_bf16_f32 v43, v34, v35
    v_mfma_f32_16x16x32_bf16 v[28:31], a[96:99], a[32:35], 0
    v_exp_f32 v20, v20
    v_mfma_f32_16x16x32_bf16 v[28:31], a[100:103], a[36:39], v[28:31]
    ds_read_b64_tr_b16 a[218:219], v4 offset:4352
    v_cvt_pk_bf16_f32 v72, v116, v117
    v_mfma_f32_16x16x32_bf16 v[28:31], a[104:107], a[40:43], v[28:31]
    v_exp_f32 v21, v21
    v_mfma_f32_16x16x32_bf16 v[28:31], a[108:111], a[44:47], v[28:31]
    ds_read_b64_tr_b16 a[220:221], v4 offset:8448
    v_cvt_pk_bf16_f32 v44, v20, v21
    v_mfma_f32_16x16x32_bf16 v[32:35], a[112:115], a[32:35], 0
    v_exp_f32 v22, v22
    v_mfma_f32_16x16x32_bf16 v[32:35], a[116:119], a[36:39], v[32:35]
    buffer_load_dwordx4 v11, s[20:23], s29 offen offset:1024 nt lds
    v_mfma_f32_16x16x32_bf16 v[32:35], a[120:123], a[40:43], v[32:35]
    v_exp_f32 v23, v23
    v_mfma_f32_16x16x32_bf16 v[32:35], a[124:127], a[44:47], v[32:35]
    ds_read_b64_tr_b16 a[222:223], v4 offset:12544
    v_cvt_pk_bf16_f32 v45, v22, v23
    v_mfma_f32_16x16x32_bf16 v[160:163], a[128:131], v[36:39], v[160:163]
    v_exp_f32 v24, v24
    v_mfma_f32_16x16x32_bf16 v[160:163], a[132:135], v[40:43], v[160:163]
    ds_read_b64_tr_b16 a[224:225], v3 offset:512
    v_lshlrev_b32 v118, 16, v73
    v_mfma_f32_16x16x32_bf16 v[164:167], a[136:139], v[36:39], v[164:167]
    v_exp_f32 v25, v25
    v_mfma_f32_16x16x32_bf16 v[164:167], a[140:143], v[40:43], v[164:167]
    ds_read_b64_tr_b16 a[226:227], v3 offset:4608
    v_cvt_pk_bf16_f32 v46, v24, v25
    v_mfma_f32_16x16x32_bf16 v[168:171], a[144:147], v[36:39], v[168:171]
    v_exp_f32 v26, v26
    v_mfma_f32_16x16x32_bf16 v[168:171], a[148:151], v[40:43], v[168:171]
    buffer_load_dwordx4 v12, s[20:23], s29 offen offset:2048 nt lds
    v_mfma_f32_16x16x32_bf16 v[172:175], a[152:155], v[36:39], v[172:175]
    v_exp_f32 v27, v27
    v_mfma_f32_16x16x32_bf16 v[172:175], a[156:159], v[40:43], v[172:175]
    ds_read_b64_tr_b16 a[228:229], v3 offset:8704
    v_cvt_pk_bf16_f32 v47, v26, v27
    v_mfma_f32_16x16x32_bf16 v[176:179], a[160:163], v[36:39], v[176:179]
    v_exp_f32 v28, v28
    v_mfma_f32_16x16x32_bf16 v[176:179], a[164:167], v[40:43], v[176:179]
    ds_read_b64_tr_b16 a[230:231], v3 offset:12800
    v_and_b32 v119, s34, v73
    v_mfma_f32_16x16x32_bf16 v[180:183], a[168:171], v[36:39], v[180:183]
    v_exp_f32 v29, v29
    v_mfma_f32_16x16x32_bf16 v[180:183], a[172:175], v[40:43], v[180:183]
    ds_read_b64_tr_b16 a[232:233], v4 offset:512
    v_cvt_pk_bf16_f32 v48, v28, v29
    v_mfma_f32_16x16x32_bf16 v[184:187], a[176:179], v[36:39], v[184:187]
    v_exp_f32 v30, v30
    v_mfma_f32_16x16x32_bf16 v[184:187], a[180:183], v[40:43], v[184:187]
    buffer_load_dwordx4 v13, s[20:23], s29 offen offset:3072 nt lds
    v_mfma_f32_16x16x32_bf16 v[188:191], a[184:187], v[36:39], v[188:191]
    v_exp_f32 v31, v31
    v_mfma_f32_16x16x32_bf16 v[188:191], a[188:191], v[40:43], v[188:191]
    ds_read_b64_tr_b16 a[234:235], v4 offset:4608
    v_cvt_pk_bf16_f32 v49, v30, v31
    v_smfmac_f32_16x16x64_bf16 v[56:59], v[16:19], v[36:43], v14
    ds_read_b64_tr_b16 a[236:237], v4 offset:8704
    s_add_u32 s29, s29, 16384
    v_mfma_f32_16x16x32_bf16 v[20:23], a[64:67], a[48:51], 0
    v_exp_f32 v32, v32
    v_mfma_f32_16x16x32_bf16 v[20:23], a[68:71], a[52:55], v[20:23]
    ds_read_b128 a[64:67], v2 offset:0
    ds_read_b128 a[68:71], v2 offset:256
    v_mfma_f32_16x16x32_bf16 v[20:23], a[72:75], a[56:59], v[20:23]
    v_exp_f32 v33, v33
    v_mfma_f32_16x16x32_bf16 v[20:23], a[76:79], a[60:63], v[20:23]
    ds_read_b128 a[72:75], v2 offset:512
    v_cvt_pk_bf16_f32 v50, v32, v33
    v_mfma_f32_16x16x32_bf16 v[24:27], a[80:83], a[48:51], 0
    v_exp_f32 v34, v34
    v_mfma_f32_16x16x32_bf16 v[24:27], a[84:87], a[52:55], v[24:27]
    ds_read_b128 a[76:79], v2 offset:768
    s_add_u32 s30, s30, s32
    v_mfma_f32_16x16x32_bf16 v[24:27], a[88:91], a[56:59], v[24:27]
    v_exp_f32 v35, v35
    v_mfma_f32_16x16x32_bf16 v[24:27], a[92:95], a[60:63], v[24:27]
    ds_read_b128 a[80:83], v2 offset:4096
    v_cvt_pk_bf16_f32 v51, v34, v35
    v_mfma_f32_16x16x32_bf16 v[28:31], a[96:99], a[48:51], 0
    v_exp_f32 v20, v20
    v_mfma_f32_16x16x32_bf16 v[28:31], a[100:103], a[52:55], v[28:31]
    ds_read_b128 a[84:87], v2 offset:4352
    v_mul_f32 v118, s28, v118
    v_mfma_f32_16x16x32_bf16 v[28:31], a[104:107], a[56:59], v[28:31]
    v_exp_f32 v21, v21
    v_mfma_f32_16x16x32_bf16 v[28:31], a[108:111], a[60:63], v[28:31]
    ds_read_b128 a[88:91], v2 offset:4608
    v_cvt_pk_bf16_f32 v36, v20, v21
    v_mfma_f32_16x16x32_bf16 v[32:35], a[112:115], a[48:51], 0
    v_exp_f32 v22, v22
    v_mfma_f32_16x16x32_bf16 v[32:35], a[116:119], a[52:55], v[32:35]
    ds_read_b128 a[92:95], v2 offset:4864
    v_mul_f32 v119, s28, v119
    v_mfma_f32_16x16x32_bf16 v[32:35], a[120:123], a[56:59], v[32:35]
    v_exp_f32 v23, v23
    v_mfma_f32_16x16x32_bf16 v[32:35], a[124:127], a[60:63], v[32:35]
    ds_read_b128 a[96:99], v2 offset:8192
    v_cvt_pk_bf16_f32 v37, v22, v23
    v_mfma_f32_16x16x32_bf16 v[192:195], a[128:131], v[44:47], v[192:195]
    v_exp_f32 v24, v24
    v_mfma_f32_16x16x32_bf16 v[192:195], a[132:135], v[48:51], v[192:195]
    ds_read_b128 a[100:103], v2 offset:8448
    v_cvt_pk_bf16_f32 v73, v118, v119
    v_mfma_f32_16x16x32_bf16 v[196:199], a[136:139], v[44:47], v[196:199]
    v_exp_f32 v25, v25
    v_mfma_f32_16x16x32_bf16 v[196:199], a[140:143], v[48:51], v[196:199]
    ds_read_b128 a[104:107], v2 offset:8704
    v_cvt_pk_bf16_f32 v38, v24, v25
    v_mfma_f32_16x16x32_bf16 v[200:203], a[144:147], v[44:47], v[200:203]
    v_exp_f32 v26, v26
    v_mfma_f32_16x16x32_bf16 v[200:203], a[148:151], v[48:51], v[200:203]
    ds_read_b128 a[108:111], v2 offset:8960
    v_lshlrev_b32 v116, 16, v74
    v_mfma_f32_16x16x32_bf16 v[204:207], a[152:155], v[44:47], v[204:207]
    v_exp_f32 v27, v27
    v_mfma_f32_16x16x32_bf16 v[204:207], a[156:159], v[48:51], v[204:207]
    ds_read_b128 a[112:115], v2 offset:12288
    v_cvt_pk_bf16_f32 v39, v26, v27
    v_mfma_f32_16x16x32_bf16 v[208:211], a[160:163], v[44:47], v[208:211]
    v_exp_f32 v28, v28
    v_mfma_f32_16x16x32_bf16 v[208:211], a[164:167], v[48:51], v[208:211]
    ds_read_b128 a[116:119], v2 offset:12544
    v_and_b32 v117, s34, v74
    v_mfma_f32_16x16x32_bf16 v[212:215], a[168:171], v[44:47], v[212:215]
    v_exp_f32 v29, v29
    v_mfma_f32_16x16x32_bf16 v[212:215], a[172:175], v[48:51], v[212:215]
    ds_read_b128 a[120:123], v2 offset:12800
    v_cvt_pk_bf16_f32 v40, v28, v29
    v_mfma_f32_16x16x32_bf16 v[216:219], a[176:179], v[44:47], v[216:219]
    v_exp_f32 v30, v30
    v_mfma_f32_16x16x32_bf16 v[216:219], a[180:183], v[48:51], v[216:219]
    ds_read_b128 a[124:127], v2 offset:13056
    v_mul_f32 v116, s28, v116
    v_mfma_f32_16x16x32_bf16 v[220:223], a[184:187], v[44:47], v[220:223]
    v_exp_f32 v31, v31
    v_mfma_f32_16x16x32_bf16 v[220:223], a[188:191], v[48:51], v[220:223]
    v_cvt_pk_bf16_f32 v41, v30, v31
    v_mul_f32 v117, s28, v117
    v_smfmac_f32_16x16x64_bf16 v[60:63], v[16:19], v[44:51], v14
    s_waitcnt lgkmcnt(4)
    v_cvt_pk_bf16_f32 v74, v116, v117
    v_mfma_f32_16x16x32_bf16 v[20:23], a[64:67], a[0:3], 0
    v_exp_f32 v32, v32
    v_mfma_f32_16x16x32_bf16 v[20:23], a[68:71], a[4:7], v[20:23]
    ds_read_b64_tr_b16 a[238:239], v4 offset:12800
    v_lshlrev_b32 v118, 16, v75
    v_mfma_f32_16x16x32_bf16 v[20:23], a[72:75], a[8:11], v[20:23]
    v_exp_f32 v33, v33
    v_mfma_f32_16x16x32_bf16 v[20:23], a[76:79], a[12:15], v[20:23]
    ds_read_b64_tr_b16 a[240:241], v3 offset:768
    v_cvt_pk_bf16_f32 v42, v32, v33
    v_mfma_f32_16x16x32_bf16 v[24:27], a[80:83], a[0:3], 0
    v_exp_f32 v34, v34
    v_mfma_f32_16x16x32_bf16 v[24:27], a[84:87], a[4:7], v[24:27]
    ds_read_b64_tr_b16 a[242:243], v3 offset:4864
    v_and_b32 v119, s34, v75
    v_mfma_f32_16x16x32_bf16 v[24:27], a[88:91], a[8:11], v[24:27]
    v_exp_f32 v35, v35
    v_mfma_f32_16x16x32_bf16 v[24:27], a[92:95], a[12:15], v[24:27]
    ds_read_b64_tr_b16 a[244:245], v3 offset:8960
    v_cvt_pk_bf16_f32 v43, v34, v35
    v_mfma_f32_16x16x32_bf16 v[28:31], a[96:99], a[0:3], 0
    v_exp_f32 v20, v20
    v_mfma_f32_16x16x32_bf16 v[28:31], a[100:103], a[4:7], v[28:31]
    ds_read_b64_tr_b16 a[246:247], v3 offset:13056
    v_mul_f32 v118, s28, v118
    v_mfma_f32_16x16x32_bf16 v[28:31], a[104:107], a[8:11], v[28:31]
    v_exp_f32 v21, v21
    v_mfma_f32_16x16x32_bf16 v[28:31], a[108:111], a[12:15], v[28:31]
    v_cvt_pk_bf16_f32 v44, v20, v21
    s_waitcnt lgkmcnt(5)
    v_mfma_f32_16x16x32_bf16 v[32:35], a[112:115], a[0:3], 0
    v_exp_f32 v22, v22
    v_mfma_f32_16x16x32_bf16 v[32:35], a[116:119], a[4:7], v[32:35]
    ds_read_b64_tr_b16 a[248:249], v4 offset:768
    v_mul_f32 v119, s28, v119
    v_mfma_f32_16x16x32_bf16 v[32:35], a[120:123], a[8:11], v[32:35]
    v_exp_f32 v23, v23
    v_mfma_f32_16x16x32_bf16 v[32:35], a[124:127], a[12:15], v[32:35]
    ds_read_b64_tr_b16 a[250:251], v4 offset:4864
    v_cvt_pk_bf16_f32 v45, v22, v23
    v_mfma_f32_16x16x32_bf16 v[224:227], a[128:131], v[36:39], v[224:227]
    v_exp_f32 v24, v24
    v_mfma_f32_16x16x32_bf16 v[224:227], a[132:135], v[40:43], v[224:227]
    ds_read_b64_tr_b16 a[252:253], v4 offset:8960
    v_cvt_pk_bf16_f32 v75, v118, v119
    v_mfma_f32_16x16x32_bf16 v[228:231], a[136:139], v[36:39], v[228:231]
    v_exp_f32 v25, v25
    v_mfma_f32_16x16x32_bf16 v[228:231], a[140:143], v[40:43], v[228:231]
    ds_read_b64_tr_b16 a[254:255], v4 offset:13056
    v_cvt_pk_bf16_f32 v46, v24, v25
    v_mfma_f32_16x16x32_bf16 v[232:235], a[144:147], v[36:39], v[232:235]
    v_exp_f32 v26, v26
    v_mfma_f32_16x16x32_bf16 v[232:235], a[148:151], v[40:43], v[232:235]
    ds_write_b128 v15, v[72:75] offset:1024
    v_mfma_f32_16x16x32_bf16 v[236:239], a[152:155], v[36:39], v[236:239]
    v_exp_f32 v27, v27
    v_mfma_f32_16x16x32_bf16 v[236:239], a[156:159], v[40:43], v[236:239]
    v_cvt_pk_bf16_f32 v47, v26, v27
    buffer_load_dwordx4 v[72:75], v1, s[12:15], s36 offen offset:1024 nt
    s_add_u32 s36, s36, 2048
    v_mfma_f32_16x16x32_bf16 v[240:243], a[160:163], v[36:39], v[240:243]
    v_exp_f32 v28, v28
    v_mfma_f32_16x16x32_bf16 v[240:243], a[164:167], v[40:43], v[240:243]
    s_cmp_eq_u32 s30, s31
    s_cselect_b32 s32, 0xffff8000, s38
    v_mfma_f32_16x16x32_bf16 v[244:247], a[168:171], v[36:39], v[244:247]
    v_exp_f32 v29, v29
    v_mfma_f32_16x16x32_bf16 v[244:247], a[172:175], v[40:43], v[244:247]
    v_cvt_pk_bf16_f32 v48, v28, v29
    v_add_u32 v3, s32, v3
    v_mfma_f32_16x16x32_bf16 v[248:251], a[176:179], v[36:39], v[248:251]
    v_exp_f32 v30, v30
    v_mfma_f32_16x16x32_bf16 v[248:251], a[180:183], v[40:43], v[248:251]
    v_add_u32 v4, s32, v4
    v_add_u32 v2, s32, v2
    v_mfma_f32_16x16x32_bf16 v[252:255], a[184:187], v[36:39], v[252:255]
    v_exp_f32 v31, v31
    v_mfma_f32_16x16x32_bf16 v[252:255], a[188:191], v[40:43], v[252:255]
    v_cvt_pk_bf16_f32 v49, v30, v31
    s_cmp_lg_u32 s29, 294912
    v_smfmac_f32_16x16x64_bf16 v[64:67], v[16:19], v[36:43], v14
    v_xor_b32 v1, 16, v1
    v_add_u32 v15, 2048, v15
    s_cbranch_scc1 LOOPQ
    v_mfma_f32_16x16x32_bf16 v[20:23], a[64:67], a[16:19], 0
    v_exp_f32 v32, v32
    v_mfma_f32_16x16x32_bf16 v[20:23], a[68:71], a[20:23], v[20:23]
    s_waitcnt vmcnt(10) lgkmcnt(1)
    s_barrier
    v_mfma_f32_16x16x32_bf16 v[20:23], a[72:75], a[24:27], v[20:23]
    v_exp_f32 v33, v33
    v_mfma_f32_16x16x32_bf16 v[20:23], a[76:79], a[28:31], v[20:23]
    v_cvt_pk_bf16_f32 v50, v32, v33
    s_mov_b32 m0, s30
    v_mfma_f32_16x16x32_bf16 v[24:27], a[80:83], a[16:19], 0
    v_exp_f32 v34, v34
    v_mfma_f32_16x16x32_bf16 v[24:27], a[84:87], a[20:23], v[24:27]
    buffer_load_dwordx4 v10, s[16:19], s29 offen offset:0 nt lds
    v_mfma_f32_16x16x32_bf16 v[24:27], a[88:91], a[24:27], v[24:27]
    v_exp_f32 v35, v35
    v_mfma_f32_16x16x32_bf16 v[24:27], a[92:95], a[28:31], v[24:27]
    ds_read_b64_tr_b16 a[128:129], v3 offset:0
    v_cvt_pk_bf16_f32 v51, v34, v35
    v_mfma_f32_16x16x32_bf16 v[28:31], a[96:99], a[16:19], 0
    v_exp_f32 v20, v20
    v_mfma_f32_16x16x32_bf16 v[28:31], a[100:103], a[20:23], v[28:31]
    ds_read_b64_tr_b16 a[130:131], v3 offset:4096
    ds_read_b64_tr_b16 a[132:133], v3 offset:8192
    v_mfma_f32_16x16x32_bf16 v[28:31], a[104:107], a[24:27], v[28:31]
    v_exp_f32 v21, v21
    v_mfma_f32_16x16x32_bf16 v[28:31], a[108:111], a[28:31], v[28:31]
    ds_read_b64_tr_b16 a[134:135], v3 offset:12288
    v_cvt_pk_bf16_f32 v36, v20, v21
    v_mfma_f32_16x16x32_bf16 v[32:35], a[112:115], a[16:19], 0
    v_exp_f32 v22, v22
    v_mfma_f32_16x16x32_bf16 v[32:35], a[116:119], a[20:23], v[32:35]
    buffer_load_dwordx4 v11, s[16:19], s29 offen offset:1024 nt lds
    ds_read_b128 a[0:3], v5 offset:0
    v_mfma_f32_16x16x32_bf16 v[32:35], a[120:123], a[24:27], v[32:35]
    v_exp_f32 v23, v23
    v_mfma_f32_16x16x32_bf16 v[32:35], a[124:127], a[28:31], v[32:35]
PG2:
    s_cbranch_vccnz BODY
    ds_read_b64_tr_b16 a[136:137], v4 offset:0
    v_cvt_pk_bf16_f32 v37, v22, v23
    ds_read_b128 a[4:7], v5 offset:256
    v_mfma_f32_16x16x32_bf16 v[128:131], a[192:195], v[44:47], v[128:131]
    v_exp_f32 v24, v24
    v_mfma_f32_16x16x32_bf16 v[128:131], a[196:199], v[48:51], v[128:131]
    ds_read_b64_tr_b16 a[138:139], v4 offset:4096
    ds_read_b64_tr_b16 a[140:141], v4 offset:8192
    ds_read_b128 a[8:11], v5 offset:512
    v_mfma_f32_16x16x32_bf16 v[132:135], a[200:203], v[44:47], v[132:135]
    v_exp_f32 v25, v25
    v_mfma_f32_16x16x32_bf16 v[132:135], a[204:207], v[48:51], v[132:135]
    ds_read_b64_tr_b16 a[142:143], v4 offset:12288
    v_cvt_pk_bf16_f32 v38, v24, v25
    ds_read_b128 a[12:15], v5 offset:768
    v_mfma_f32_16x16x32_bf16 v[136:139], a[208:211], v[44:47], v[136:139]
    v_exp_f32 v26, v26
    v_mfma_f32_16x16x32_bf16 v[136:139], a[212:215], v[48:51], v[136:139]
    buffer_load_dwordx4 v12, s[16:19], s29 offen offset:2048 nt lds
    v_mfma_f32_16x16x32_bf16 v[140:143], a[216:219], v[44:47], v[140:143]
    v_exp_f32 v27, v27
    v_mfma_f32_16x16x32_bf16 v[140:143], a[220:223], v[48:51], v[140:143]
    ds_read_b64_tr_b16 a[144:145], v3 offset:256
    v_cvt_pk_bf16_f32 v39, v26, v27
    ds_read_b128 a[16:19], v5 offset:4096
    s_waitcnt vmcnt(12)
    v_lshlrev_b32 v116, 16, v68
    v_mfma_f32_16x16x32_bf16 v[144:147], a[224:227], v[44:47], v[144:147]
    v_exp_f32 v28, v28
    v_mfma_f32_16x16x32_bf16 v[144:147], a[228:231], v[48:51], v[144:147]
    ds_read_b64_tr_b16 a[146:147], v3 offset:4352
    ds_read_b64_tr_b16 a[148:149], v3 offset:8448
    ds_read_b128 a[20:23], v5 offset:4352
    v_and_b32 v117, s34, v68
    v_mul_f32 v116, s28, v116
    v_mul_f32 v117, s28, v117
    v_mfma_f32_16x16x32_bf16 v[148:151], a[232:235], v[44:47], v[148:151]
    v_exp_f32 v29, v29
    v_mfma_f32_16x16x32_bf16 v[148:151], a[236:239], v[48:51], v[148:151]
    ds_read_b64_tr_b16 a[150:151], v3 offset:12544
    v_cvt_pk_bf16_f32 v40, v28, v29
    ds_read_b128 a[24:27], v5 offset:4608
    v_cvt_pk_bf16_f32 v68, v116, v117
    v_lshlrev_b32 v118, 16, v69
    v_mfma_f32_16x16x32_bf16 v[152:155], a[240:243], v[44:47], v[152:155]
    v_exp_f32 v30, v30
    v_mfma_f32_16x16x32_bf16 v[152:155], a[244:247], v[48:51], v[152:155]
    buffer_load_dwordx4 v13, s[16:19], s29 offen offset:3072 nt lds
    ds_read_b128 a[28:31], v5 offset:4864
    v_and_b32 v119, s34, v69
    v_mul_f32 v118, s28, v118
    v_mul_f32 v119, s28, v119
    v_mfma_f32_16x16x32_bf16 v[156:159], a[248:251], v[44:47], v[156:159]
    v_exp_f32 v31, v31
    v_mfma_f32_16x16x32_bf16 v[156:159], a[252:255], v[48:51], v[156:159]
    ds_read_b64_tr_b16 a[152:153], v4 offset:256
    v_cvt_pk_bf16_f32 v41, v30, v31
    v_cvt_pk_bf16_f32 v69, v118, v119
    v_lshlrev_b32 v116, 16, v70
    v_smfmac_f32_16x16x64_bf16 v[52:55], v[16:19], v[44:51], v14
    ds_read_b64_tr_b16 a[154:155], v4 offset:4352
    ds_read_b64_tr_b16 a[156:157], v4 offset:8448
    v_and_b32 v117, s34, v70
    v_mul_f32 v116, s28, v116
    v_mul_f32 v117, s28, v117
    v_mfma_f32_16x16x32_bf16 v[20:23], a[64:67], a[32:35], 0
    v_exp_f32 v32, v32
    v_mfma_f32_16x16x32_bf16 v[20:23], a[68:71], a[36:39], v[20:23]
    ds_read_b64_tr_b16 a[158:159], v4 offset:12544
    ds_read_b64_tr_b16 a[160:161], v3 offset:512
    v_cvt_pk_bf16_f32 v70, v116, v117
    v_lshlrev_b32 v118, 16, v71
    v_mfma_f32_16x16x32_bf16 v[20:23], a[72:75], a[40:43], v[20:23]
    v_exp_f32 v33, v33
    v_mfma_f32_16x16x32_bf16 v[20:23], a[76:79], a[44:47], v[20:23]
    v_cvt_pk_bf16_f32 v42, v32, v33
    s_add_u32 m0, s30, 49152
    v_and_b32 v119, s34, v71
    v_mul_f32 v118, s28, v118
    v_mul_f32 v119, s28, v119
    v_mfma_f32_16x16x32_bf16 v[24:27], a[80:83], a[32:35], 0
    v_exp_f32 v34, v34
    v_mfma_f32_16x16x32_bf16 v[24:27], a[84:87], a[36:39], v[24:27]
    buffer_load_dwordx4 v10, s[20:23], s29 offen offset:0 nt lds
    v_cvt_pk_bf16_f32 v71, v118, v119
    ds_write_b128 v15, v[68:71] offset:0
    v_mfma_f32_16x16x32_bf16 v[24:27], a[88:91], a[40:43], v[24:27]
    v_exp_f32 v35, v35
    v_mfma_f32_16x16x32_bf16 v[24:27], a[92:95], a[44:47], v[24:27]
    ds_read_b64_tr_b16 a[162:163], v3 offset:4608
    v_cvt_pk_bf16_f32 v43, v34, v35
    v_add_f32 v120, v52, v53
    v_rcp_f32 v122, v120
    v_mfma_f32_16x16x32_bf16 v[28:31], a[96:99], a[32:35], 0
    v_exp_f32 v20, v20
    v_mfma_f32_16x16x32_bf16 v[28:31], a[100:103], a[36:39], v[28:31]
    ds_read_b64_tr_b16 a[164:165], v3 offset:8704
    ds_read_b64_tr_b16 a[166:167], v3 offset:12800
    v_subrev_u32 v120, s35, v120
    v_max_u32 v9, v9, v120
    v_mfma_f32_16x16x32_bf16 v[28:31], a[104:107], a[40:43], v[28:31]
    v_exp_f32 v21, v21
    v_mfma_f32_16x16x32_bf16 v[28:31], a[108:111], a[44:47], v[28:31]
    ds_read_b64_tr_b16 a[168:169], v4 offset:512
    v_cvt_pk_bf16_f32 v44, v20, v21
    v_mov_b32 v52, 0
    v_mov_b32 v53, 0
    v_mfma_f32_16x16x32_bf16 v[32:35], a[112:115], a[32:35], 0
    v_exp_f32 v22, v22
    v_mfma_f32_16x16x32_bf16 v[32:35], a[116:119], a[36:39], v[32:35]
    buffer_load_dwordx4 v11, s[20:23], s29 offen offset:1024 nt lds
    v_pk_mul_f32 v[128:129], v[128:129], v[122:123] op_sel_hi:[1,0]
    v_pk_mul_f32 v[130:131], v[130:131], v[122:123] op_sel_hi:[1,0]
    v_pk_mul_f32 v[144:145], v[144:145], v[122:123] op_sel_hi:[1,0]
    v_pk_mul_f32 v[146:147], v[146:147], v[122:123] op_sel_hi:[1,0]
    v_pk_mul_f32 v[132:133], v[132:133], v[122:123] op_sel_hi:[1,0]
    v_pk_mul_f32 v[134:135], v[134:135], v[122:123] op_sel_hi:[1,0]
    v_pk_mul_f32 v[148:149], v[148:149], v[122:123] op_sel_hi:[1,0]
    v_pk_mul_f32 v[150:151], v[150:151], v[122:123] op_sel_hi:[1,0]
    v_pk_mul_f32 v[136:137], v[136:137], v[122:123] op_sel_hi:[1,0]
    v_pk_mul_f32 v[138:139], v[138:139], v[122:123] op_sel_hi:[1,0]
    v_pk_mul_f32 v[152:153], v[152:153], v[122:123] op_sel_hi:[1,0]
    v_pk_mul_f32 v[154:155], v[154:155], v[122:123] op_sel_hi:[1,0]
    v_pk_mul_f32 v[140:141], v[140:141], v[122:123] op_sel_hi:[1,0]
    v_pk_mul_f32 v[142:143], v[142:143], v[122:123] op_sel_hi:[1,0]
    v_pk_mul_f32 v[156:157], v[156:157], v[122:123] op_sel_hi:[1,0]
    v_pk_mul_f32 v[158:159], v[158:159], v[122:123] op_sel_hi:[1,0]
    v_mfma_f32_16x16x32_bf16 v[32:35], a[120:123], a[40:43], v[32:35]
    v_exp_f32 v23, v23
    v_mfma_f32_16x16x32_bf16 v[32:35], a[124:127], a[44:47], v[32:35]
    ds_read_b64_tr_b16 a[170:171], v4 offset:4608
    v_cvt_pk_bf16_f32 v45, v22, v23
    v_cvt_pk_bf16_f32 v84, v128, v129
    v_mfma_f32_16x16x32_bf16 v[160:163], a[192:195], v[36:39], v[160:163]
    v_exp_f32 v24, v24
    v_mfma_f32_16x16x32_bf16 v[160:163], a[196:199], v[40:43], v[160:163]
    ds_read_b64_tr_b16 a[172:173], v4 offset:8704
    ds_read_b64_tr_b16 a[174:175], v4 offset:12800
    v_cvt_pk_bf16_f32 v85, v130, v131
    v_mfma_f32_16x16x32_bf16 v[164:167], a[200:203], v[36:39], v[164:167]
    v_exp_f32 v25, v25
    v_mfma_f32_16x16x32_bf16 v[164:167], a[204:207], v[40:43], v[164:167]
    ds_read_b64_tr_b16 a[176:177], v3 offset:768
    v_cvt_pk_bf16_f32 v46, v24, v25
    v_cvt_pk_bf16_f32 v92, v144, v145
    v_mfma_f32_16x16x32_bf16 v[168:171], a[208:211], v[36:39], v[168:171]
    v_exp_f32 v26, v26
    v_mfma_f32_16x16x32_bf16 v[168:171], a[212:215], v[40:43], v[168:171]
    buffer_load_dwordx4 v12, s[20:23], s29 offen offset:2048 nt lds
    v_cvt_pk_bf16_f32 v93, v146, v147
    v_mfma_f32_16x16x32_bf16 v[172:175], a[216:219], v[36:39], v[172:175]
    v_exp_f32 v27, v27
    v_mfma_f32_16x16x32_bf16 v[172:175], a[220:223], v[40:43], v[172:175]
    ds_read_b64_tr_b16 a[178:179], v3 offset:4864
    v_cvt_pk_bf16_f32 v47, v26, v27
    ds_read_b128 a[32:35], v5 offset:8192
    v_mfma_f32_16x16x32_bf16 v[176:179], a[224:227], v[36:39], v[176:179]
    v_exp_f32 v28, v28
    v_mfma_f32_16x16x32_bf16 v[176:179], a[228:231], v[40:43], v[176:179]
    ds_read_b64_tr_b16 a[180:181], v3 offset:8960
    ds_read_b64_tr_b16 a[182:183], v3 offset:13056
    ds_read_b128 a[36:39], v5 offset:8448
    v_cvt_pk_bf16_f32 v86, v132, v133
    v_mfma_f32_16x16x32_bf16 v[180:183], a[232:235], v[36:39], v[180:183]
    v_exp_f32 v29, v29
    v_mfma_f32_16x16x32_bf16 v[180:183], a[236:239], v[40:43], v[180:183]
    ds_read_b64_tr_b16 a[184:185], v4 offset:768
    v_cvt_pk_bf16_f32 v48, v28, v29
    ds_read_b128 a[40:43], v5 offset:8704
    v_cvt_pk_bf16_f32 v87, v134, v135
    v_mfma_f32_16x16x32_bf16 v[184:187], a[240:243], v[36:39], v[184:187]
    v_exp_f32 v30, v30
    v_mfma_f32_16x16x32_bf16 v[184:187], a[244:247], v[40:43], v[184:187]
    buffer_load_dwordx4 v13, s[20:23], s29 offen offset:3072 nt lds
    ds_read_b128 a[44:47], v5 offset:8960
    v_cvt_pk_bf16_f32 v94, v148, v149
    v_mfma_f32_16x16x32_bf16 v[188:191], a[248:251], v[36:39], v[188:191]
    v_exp_f32 v31, v31
    v_mfma_f32_16x16x32_bf16 v[188:191], a[252:255], v[40:43], v[188:191]
    ds_read_b64_tr_b16 a[186:187], v4 offset:4864
    v_cvt_pk_bf16_f32 v49, v30, v31
    v_cvt_pk_bf16_f32 v95, v150, v151
    v_smfmac_f32_16x16x64_bf16 v[56:59], v[16:19], v[36:43], v14
    ds_read_b64_tr_b16 a[188:189], v4 offset:8960
    ds_read_b64_tr_b16 a[190:191], v4 offset:13056
    v_cvt_pk_bf16_f32 v88, v136, v137
    v_mfma_f32_16x16x32_bf16 v[20:23], a[64:67], a[48:51], 0
    v_exp_f32 v32, v32
    v_mfma_f32_16x16x32_bf16 v[20:23], a[68:71], a[52:55], v[20:23]
    ds_read_b128 a[64:67], v2 offset:0
    ds_read_b128 a[68:71], v2 offset:256
    v_cvt_pk_bf16_f32 v89, v138, v139
    v_mfma_f32_16x16x32_bf16 v[20:23], a[72:75], a[56:59], v[20:23]
    v_exp_f32 v33, v33
    v_mfma_f32_16x16x32_bf16 v[20:23], a[76:79], a[60:63], v[20:23]
    ds_read_b128 a[72:75], v2 offset:512
    v_cvt_pk_bf16_f32 v50, v32, v33
    v_cvt_pk_bf16_f32 v96, v152, v153
    v_mfma_f32_16x16x32_bf16 v[24:27], a[80:83], a[48:51], 0
    v_exp_f32 v34, v34
    v_mfma_f32_16x16x32_bf16 v[24:27], a[84:87], a[52:55], v[24:27]
    ds_read_b128 a[76:79], v2 offset:768
    s_add_u32 s29, s29, 16384
    v_mfma_f32_16x16x32_bf16 v[24:27], a[88:91], a[56:59], v[24:27]
    v_exp_f32 v35, v35
    v_mfma_f32_16x16x32_bf16 v[24:27], a[92:95], a[60:63], v[24:27]
    ds_read_b128 a[80:83], v2 offset:4096
    v_cvt_pk_bf16_f32 v51, v34, v35
    v_cvt_pk_bf16_f32 v97, v154, v155
    v_mfma_f32_16x16x32_bf16 v[28:31], a[96:99], a[48:51], 0
    v_exp_f32 v20, v20
    v_mfma_f32_16x16x32_bf16 v[28:31], a[100:103], a[52:55], v[28:31]
    ds_read_b128 a[84:87], v2 offset:4352
    s_add_u32 s30, s30, s32
    v_cvt_pk_bf16_f32 v90, v140, v141
    v_mfma_f32_16x16x32_bf16 v[28:31], a[104:107], a[56:59], v[28:31]
    v_exp_f32 v21, v21
    v_mfma_f32_16x16x32_bf16 v[28:31], a[108:111], a[60:63], v[28:31]
    ds_read_b128 a[88:91], v2 offset:4608
    v_cvt_pk_bf16_f32 v36, v20, v21
    v_cvt_pk_bf16_f32 v91, v142, v143
    v_mfma_f32_16x16x32_bf16 v[32:35], a[112:115], a[48:51], 0
    v_exp_f32 v22, v22
    v_mfma_f32_16x16x32_bf16 v[32:35], a[116:119], a[52:55], v[32:35]
    ds_read_b128 a[92:95], v2 offset:4864
    v_cvt_pk_bf16_f32 v98, v156, v157
    v_cvt_pk_bf16_f32 v99, v158, v159
    v_mfma_f32_16x16x32_bf16 v[32:35], a[120:123], a[56:59], v[32:35]
    v_exp_f32 v23, v23
    v_mfma_f32_16x16x32_bf16 v[32:35], a[124:127], a[60:63], v[32:35]
    ds_read_b128 a[96:99], v2 offset:8192
    v_cvt_pk_bf16_f32 v37, v22, v23
    v_add_f32 v120, v56, v57
    v_rcp_f32 v122, v120
    v_mfma_f32_16x16x32_bf16 v[192:195], a[192:195], v[44:47], v[192:195]
    v_exp_f32 v24, v24
    v_mfma_f32_16x16x32_bf16 v[192:195], a[196:199], v[48:51], v[192:195]
    ds_read_b128 a[100:103], v2 offset:8448
    v_subrev_u32 v120, s35, v120
    v_max_u32 v9, v9, v120
    v_mfma_f32_16x16x32_bf16 v[196:199], a[200:203], v[44:47], v[196:199]
    v_exp_f32 v25, v25
    v_mfma_f32_16x16x32_bf16 v[196:199], a[204:207], v[48:51], v[196:199]
    ds_read_b128 a[104:107], v2 offset:8704
    v_cvt_pk_bf16_f32 v38, v24, v25
    v_mov_b32 v56, 0
    v_mov_b32 v57, 0
    v_mfma_f32_16x16x32_bf16 v[200:203], a[208:211], v[44:47], v[200:203]
    v_exp_f32 v26, v26
    v_pk_mul_f32 v[160:161], v[160:161], v[122:123] op_sel_hi:[1,0]
    v_pk_mul_f32 v[162:163], v[162:163], v[122:123] op_sel_hi:[1,0]
    v_pk_mul_f32 v[176:177], v[176:177], v[122:123] op_sel_hi:[1,0]
    v_pk_mul_f32 v[178:179], v[178:179], v[122:123] op_sel_hi:[1,0]
    v_pk_mul_f32 v[164:165], v[164:165], v[122:123] op_sel_hi:[1,0]
    v_pk_mul_f32 v[166:167], v[166:167], v[122:123] op_sel_hi:[1,0]
    v_pk_mul_f32 v[180:181], v[180:181], v[122:123] op_sel_hi:[1,0]
    v_pk_mul_f32 v[182:183], v[182:183], v[122:123] op_sel_hi:[1,0]
    v_pk_mul_f32 v[168:169], v[168:169], v[122:123] op_sel_hi:[1,0]
    v_pk_mul_f32 v[170:171], v[170:171], v[122:123] op_sel_hi:[1,0]
    v_pk_mul_f32 v[184:185], v[184:185], v[122:123] op_sel_hi:[1,0]
    v_pk_mul_f32 v[186:187], v[186:187], v[122:123] op_sel_hi:[1,0]
    v_pk_mul_f32 v[172:173], v[172:173], v[122:123] op_sel_hi:[1,0]
    v_pk_mul_f32 v[174:175], v[174:175], v[122:123] op_sel_hi:[1,0]
    v_pk_mul_f32 v[188:189], v[188:189], v[122:123] op_sel_hi:[1,0]
    v_pk_mul_f32 v[190:191], v[190:191], v[122:123] op_sel_hi:[1,0]
    v_mfma_f32_16x16x32_bf16 v[200:203], a[212:215], v[48:51], v[200:203]
    ds_read_b128 a[108:111], v2 offset:8960
    v_cvt_pk_bf16_f32 v100, v160, v161
    v_mfma_f32_16x16x32_bf16 v[204:207], a[216:219], v[44:47], v[204:207]
    v_exp_f32 v27, v27
    v_mfma_f32_16x16x32_bf16 v[204:207], a[220:223], v[48:51], v[204:207]
    ds_read_b128 a[112:115], v2 offset:12288
    v_cvt_pk_bf16_f32 v39, v26, v27
    v_cvt_pk_bf16_f32 v101, v162, v163
    v_mfma_f32_16x16x32_bf16 v[208:211], a[224:227], v[44:47], v[208:211]
    v_exp_f32 v28, v28
    v_mfma_f32_16x16x32_bf16 v[208:211], a[228:231], v[48:51], v[208:211]
    ds_read_b128 a[116:119], v2 offset:12544
    v_cvt_pk_bf16_f32 v108, v176, v177
    v_mfma_f32_16x16x32_bf16 v[212:215], a[232:235], v[44:47], v[212:215]
    v_exp_f32 v29, v29
    v_mfma_f32_16x16x32_bf16 v[212:215], a[236:239], v[48:51], v[212:215]
    ds_read_b128 a[120:123], v2 offset:12800
    v_cvt_pk_bf16_f32 v40, v28, v29
    v_mfma_f32_16x16x32_bf16 v[216:219], a[240:243], v[44:47], v[216:219]
    v_exp_f32 v30, v30
    v_mfma_f32_16x16x32_bf16 v[216:219], a[244:247], v[48:51], v[216:219]
    ds_read_b128 a[124:127], v2 offset:13056
    v_cvt_pk_bf16_f32 v109, v178, v179
    v_mfma_f32_16x16x32_bf16 v[220:223], a[248:251], v[44:47], v[220:223]
    v_exp_f32 v31, v31
    v_mfma_f32_16x16x32_bf16 v[220:223], a[252:255], v[48:51], v[220:223]
    v_cvt_pk_bf16_f32 v41, v30, v31
    v_cvt_pk_bf16_f32 v102, v164, v165
    v_cvt_pk_bf16_f32 v103, v166, v167
    v_smfmac_f32_16x16x64_bf16 v[60:63], v[16:19], v[44:51], v14
    s_waitcnt lgkmcnt(4)
    v_cvt_pk_bf16_f32 v110, v180, v181
    v_mfma_f32_16x16x32_bf16 v[20:23], a[64:67], a[0:3], 0
    v_exp_f32 v32, v32
    v_mfma_f32_16x16x32_bf16 v[20:23], a[68:71], a[4:7], v[20:23]
    ds_write2st64_b64 v76, v[84:85], v[92:93] offset0:0 offset1:16
    v_cvt_pk_bf16_f32 v111, v182, v183
    v_mfma_f32_16x16x32_bf16 v[20:23], a[72:75], a[8:11], v[20:23]
    v_exp_f32 v33, v33
    v_mfma_f32_16x16x32_bf16 v[20:23], a[76:79], a[12:15], v[20:23]
    v_cvt_pk_bf16_f32 v42, v32, v33
    v_cvt_pk_bf16_f32 v104, v168, v169
    v_mfma_f32_16x16x32_bf16 v[24:27], a[80:83], a[0:3], 0
    v_exp_f32 v34, v34
    v_mfma_f32_16x16x32_bf16 v[24:27], a[84:87], a[4:7], v[24:27]
    ds_write2st64_b64 v77, v[86:87], v[94:95] offset0:0 offset1:16
    v_cvt_pk_bf16_f32 v105, v170, v171
    v_cvt_pk_bf16_f32 v112, v184, v185
    v_mfma_f32_16x16x32_bf16 v[24:27], a[88:91], a[8:11], v[24:27]
    v_exp_f32 v35, v35
    v_mfma_f32_16x16x32_bf16 v[24:27], a[92:95], a[12:15], v[24:27]
    v_cvt_pk_bf16_f32 v43, v34, v35
    v_cvt_pk_bf16_f32 v113, v186, v187
    v_mfma_f32_16x16x32_bf16 v[28:31], a[96:99], a[0:3], 0
    v_exp_f32 v20, v20
    v_mfma_f32_16x16x32_bf16 v[28:31], a[100:103], a[4:7], v[28:31]
    ds_write2st64_b64 v78, v[88:89], v[96:97] offset0:0 offset1:16
    v_cvt_pk_bf16_f32 v106, v172, v173
    v_mfma_f32_16x16x32_bf16 v[28:31], a[104:107], a[8:11], v[28:31]
    v_exp_f32 v21, v21
    v_mfma_f32_16x16x32_bf16 v[28:31], a[108:111], a[12:15], v[28:31]
    v_cvt_pk_bf16_f32 v44, v20, v21
    s_waitcnt lgkmcnt(3)
    v_mfma_f32_16x16x32_bf16 v[32:35], a[112:115], a[0:3], 0
    v_exp_f32 v22, v22
    v_mfma_f32_16x16x32_bf16 v[32:35], a[116:119], a[4:7], v[32:35]
    ds_write2st64_b64 v79, v[90:91], v[98:99] offset0:0 offset1:16
    v_cvt_pk_bf16_f32 v107, v174, v175
    v_cvt_pk_bf16_f32 v114, v188, v189
    v_mfma_f32_16x16x32_bf16 v[32:35], a[120:123], a[8:11], v[32:35]
    v_exp_f32 v23, v23
    v_mfma_f32_16x16x32_bf16 v[32:35], a[124:127], a[12:15], v[32:35]
    v_cvt_pk_bf16_f32 v45, v22, v23
    v_cvt_pk_bf16_f32 v115, v190, v191
    v_mfma_f32_16x16x32_bf16 v[224:227], a[192:195], v[36:39], v[224:227]
    v_exp_f32 v24, v24
    v_mfma_f32_16x16x32_bf16 v[224:227], a[196:199], v[40:43], v[224:227]
    ds_write2st64_b64 v76, v[100:101], v[108:109] offset0:4 offset1:20
    v_add_f32 v120, v60, v61
    v_rcp_f32 v122, v120
    v_mfma_f32_16x16x32_bf16 v[228:231], a[200:203], v[36:39], v[228:231]
    v_exp_f32 v25, v25
    v_mfma_f32_16x16x32_bf16 v[228:231], a[204:207], v[40:43], v[228:231]
    v_cvt_pk_bf16_f32 v46, v24, v25
    v_subrev_u32 v120, s35, v120
    v_max_u32 v9, v9, v120
    v_mfma_f32_16x16x32_bf16 v[232:235], a[208:211], v[36:39], v[232:235]
    v_exp_f32 v26, v26
    v_mfma_f32_16x16x32_bf16 v[232:235], a[212:215], v[40:43], v[232:235]
    ds_write2st64_b64 v77, v[102:103], v[110:111] offset0:4 offset1:20
    v_mov_b32 v60, 0
    v_mov_b32 v61, 0
    v_mfma_f32_16x16x32_bf16 v[236:239], a[216:219], v[36:39], v[236:239]
    v_exp_f32 v27, v27
    v_mfma_f32_16x16x32_bf16 v[236:239], a[220:223], v[40:43], v[236:239]
    v_cvt_pk_bf16_f32 v47, v26, v27
    v_pk_mul_f32 v[192:193], v[192:193], v[122:123] op_sel_hi:[1,0]
    v_pk_mul_f32 v[194:195], v[194:195], v[122:123] op_sel_hi:[1,0]
    v_pk_mul_f32 v[208:209], v[208:209], v[122:123] op_sel_hi:[1,0]
    v_pk_mul_f32 v[210:211], v[210:211], v[122:123] op_sel_hi:[1,0]
    v_pk_mul_f32 v[196:197], v[196:197], v[122:123] op_sel_hi:[1,0]
    v_pk_mul_f32 v[198:199], v[198:199], v[122:123] op_sel_hi:[1,0]
    v_pk_mul_f32 v[212:213], v[212:213], v[122:123] op_sel_hi:[1,0]
    v_pk_mul_f32 v[214:215], v[214:215], v[122:123] op_sel_hi:[1,0]
    v_pk_mul_f32 v[200:201], v[200:201], v[122:123] op_sel_hi:[1,0]
    v_pk_mul_f32 v[202:203], v[202:203], v[122:123] op_sel_hi:[1,0]
    v_pk_mul_f32 v[216:217], v[216:217], v[122:123] op_sel_hi:[1,0]
    v_pk_mul_f32 v[218:219], v[218:219], v[122:123] op_sel_hi:[1,0]
    v_pk_mul_f32 v[204:205], v[204:205], v[122:123] op_sel_hi:[1,0]
    v_pk_mul_f32 v[206:207], v[206:207], v[122:123] op_sel_hi:[1,0]
    v_pk_mul_f32 v[220:221], v[220:221], v[122:123] op_sel_hi:[1,0]
    v_pk_mul_f32 v[222:223], v[222:223], v[122:123] op_sel_hi:[1,0]
    v_mfma_f32_16x16x32_bf16 v[240:243], a[224:227], v[36:39], v[240:243]
    v_exp_f32 v28, v28
    v_mfma_f32_16x16x32_bf16 v[240:243], a[228:231], v[40:43], v[240:243]
    ds_write2st64_b64 v78, v[104:105], v[112:113] offset0:4 offset1:20
    s_cmp_eq_u32 s30, s31
    s_cselect_b32 s32, 0xffff8000, s38
    v_mfma_f32_16x16x32_bf16 v[244:247], a[232:235], v[36:39], v[244:247]
    v_exp_f32 v29, v29
    v_mfma_f32_16x16x32_bf16 v[244:247], a[236:239], v[40:43], v[244:247]
    v_cvt_pk_bf16_f32 v48, v28, v29
    v_add_u32 v3, s32, v3
    v_cvt_pk_bf16_f32 v84, v192, v193
    v_mfma_f32_16x16x32_bf16 v[248:251], a[240:243], v[36:39], v[248:251]
    v_exp_f32 v30, v30
    v_mfma_f32_16x16x32_bf16 v[248:251], a[244:247], v[40:43], v[248:251]
    ds_write2st64_b64 v79, v[106:107], v[114:115] offset0:4 offset1:20
    v_add_u32 v4, s32, v4
    v_add_u32 v2, s32, v2
    v_mfma_f32_16x16x32_bf16 v[252:255], a[248:251], v[36:39], v[252:255]
    v_exp_f32 v31, v31
    v_mfma_f32_16x16x32_bf16 v[252:255], a[252:255], v[40:43], v[252:255]
    v_cvt_pk_bf16_f32 v49, v30, v31
    v_cvt_pk_bf16_f32 v85, v194, v195
    v_cvt_pk_bf16_f32 v92, v208, v209
    v_smfmac_f32_16x16x64_bf16 v[64:67], v[16:19], v[36:43], v14
    v_cvt_pk_bf16_f32 v93, v210, v211
    v_cvt_pk_bf16_f32 v86, v196, v197
    v_mfma_f32_16x16x32_bf16 v[20:23], a[64:67], a[16:19], 0
    v_exp_f32 v32, v32
    v_mfma_f32_16x16x32_bf16 v[20:23], a[68:71], a[20:23], v[20:23]
    s_waitcnt vmcnt(9)
    s_barrier
    s_waitcnt vmcnt(8)
    v_cvt_pk_bf16_f32 v87, v198, v199
    v_mfma_f32_16x16x32_bf16 v[20:23], a[72:75], a[24:27], v[20:23]
    v_exp_f32 v33, v33
    v_mfma_f32_16x16x32_bf16 v[20:23], a[76:79], a[28:31], v[20:23]
    v_cvt_pk_bf16_f32 v50, v32, v33
    s_mov_b32 m0, s30
    v_lshlrev_b32 v116, 16, v72
    v_mfma_f32_16x16x32_bf16 v[24:27], a[80:83], a[16:19], 0
    v_exp_f32 v34, v34
    v_mfma_f32_16x16x32_bf16 v[24:27], a[84:87], a[20:23], v[24:27]
    buffer_load_dwordx4 v10, s[16:19], s29 offen offset:0 nt lds
    v_and_b32 v117, s34, v72
    v_cvt_pk_bf16_f32 v94, v212, v213
    v_mfma_f32_16x16x32_bf16 v[24:27], a[88:91], a[24:27], v[24:27]
    v_exp_f32 v35, v35
    v_mfma_f32_16x16x32_bf16 v[24:27], a[92:95], a[28:31], v[24:27]
    ds_read_b64_tr_b16 a[192:193], v3 offset:0
    v_cvt_pk_bf16_f32 v51, v34, v35
    v_mul_f32 v116, s28, v116
    v_mfma_f32_16x16x32_bf16 v[28:31], a[96:99], a[16:19], 0
    v_exp_f32 v20, v20
    v_mfma_f32_16x16x32_bf16 v[28:31], a[100:103], a[20:23], v[28:31]
    ds_read_b64_tr_b16 a[194:195], v3 offset:4096
    ds_read_b64_tr_b16 a[196:197], v3 offset:8192
    v_mul_f32 v117, s28, v117
    v_mfma_f32_16x16x32_bf16 v[28:31], a[104:107], a[24:27], v[28:31]
    v_exp_f32 v21, v21
    v_mfma_f32_16x16x32_bf16 v[28:31], a[108:111], a[28:31], v[28:31]
    ds_read_b64_tr_b16 a[198:199], v3 offset:12288
    v_cvt_pk_bf16_f32 v36, v20, v21
    v_cvt_pk_bf16_f32 v95, v214, v215
    v_mfma_f32_16x16x32_bf16 v[32:35], a[112:115], a[16:19], 0
    v_exp_f32 v22, v22
    v_mfma_f32_16x16x32_bf16 v[32:35], a[116:119], a[20:23], v[32:35]
    buffer_load_dwordx4 v11, s[16:19], s29 offen offset:1024 nt lds
    v_cvt_pk_bf16_f32 v72, v116, v117
    v_mfma_f32_16x16x32_bf16 v[32:35], a[120:123], a[24:27], v[32:35]
    v_exp_f32 v23, v23
    v_mfma_f32_16x16x32_bf16 v[32:35], a[124:127], a[28:31], v[32:35]
    ds_read_b64_tr_b16 a[200:201], v4 offset:0
    v_cvt_pk_bf16_f32 v37, v22, v23
    v_lshlrev_b32 v118, 16, v73
    ds_read_b128 v[68:71], v80 offset:0
    v_cvt_pk_bf16_f32 v88, v200, v201
    v_mfma_f32_16x16x32_bf16 v[128:131], a[128:131], v[44:47], 0
    v_exp_f32 v24, v24
    v_mfma_f32_16x16x32_bf16 v[128:131], a[132:135], v[48:51], v[128:131]
    ds_read_b64_tr_b16 a[202:203], v4 offset:4096
    ds_read_b64_tr_b16 a[204:205], v4 offset:8192
    v_and_b32 v119, s34, v73
    v_add_u32 v80, 1024, v80
    v_mfma_f32_16x16x32_bf16 v[132:135], a[136:139], v[44:47], 0
    v_exp_f32 v25, v25
    v_mfma_f32_16x16x32_bf16 v[132:135], a[140:143], v[48:51], v[132:135]
    ds_read_b64_tr_b16 a[206:207], v4 offset:12288
    v_cvt_pk_bf16_f32 v38, v24, v25
    v_mul_f32 v118, s28, v118
    v_cvt_pk_bf16_f32 v89, v202, v203
    v_mfma_f32_16x16x32_bf16 v[136:139], a[144:147], v[44:47], 0
    v_exp_f32 v26, v26
    v_mfma_f32_16x16x32_bf16 v[136:139], a[148:151], v[48:51], v[136:139]
    buffer_load_dwordx4 v12, s[16:19], s29 offen offset:2048 nt lds
    v_mul_f32 v119, s28, v119
    v_mfma_f32_16x16x32_bf16 v[140:143], a[152:155], v[44:47], 0
    v_exp_f32 v27, v27
    v_mfma_f32_16x16x32_bf16 v[140:143], a[156:159], v[48:51], v[140:143]
    ds_read_b64_tr_b16 a[208:209], v3 offset:256
    v_cvt_pk_bf16_f32 v39, v26, v27
    v_cvt_pk_bf16_f32 v73, v118, v119
    v_cvt_pk_bf16_f32 v96, v216, v217
    v_mfma_f32_16x16x32_bf16 v[144:147], a[160:163], v[44:47], 0
    v_exp_f32 v28, v28
    v_mfma_f32_16x16x32_bf16 v[144:147], a[164:167], v[48:51], v[144:147]
    ds_read_b64_tr_b16 a[210:211], v3 offset:4352
    ds_read_b64_tr_b16 a[212:213], v3 offset:8448
    v_lshlrev_b32 v116, 16, v74
    v_mfma_f32_16x16x32_bf16 v[148:151], a[168:171], v[44:47], 0
    v_exp_f32 v29, v29
    v_mfma_f32_16x16x32_bf16 v[148:151], a[172:175], v[48:51], v[148:151]
    ds_read_b64_tr_b16 a[214:215], v3 offset:12544
    v_cvt_pk_bf16_f32 v40, v28, v29
    v_and_b32 v117, s34, v74
    v_cvt_pk_bf16_f32 v97, v218, v219
    v_mfma_f32_16x16x32_bf16 v[152:155], a[176:179], v[44:47], 0
    v_exp_f32 v30, v30
    v_mfma_f32_16x16x32_bf16 v[152:155], a[180:183], v[48:51], v[152:155]
    buffer_load_dwordx4 v13, s[16:19], s29 offen offset:3072 nt lds
    v_mul_f32 v116, s28, v116
    v_mfma_f32_16x16x32_bf16 v[156:159], a[184:187], v[44:47], 0
    v_exp_f32 v31, v31
    v_mfma_f32_16x16x32_bf16 v[156:159], a[188:191], v[48:51], v[156:159]
    ds_read_b64_tr_b16 a[216:217], v4 offset:256
    v_cvt_pk_bf16_f32 v41, v30, v31
    v_mul_f32 v117, s28, v117
    v_smfmac_f32_16x16x64_bf16 v[52:55], v[16:19], v[44:51], v14
    ds_read_b64_tr_b16 a[218:219], v4 offset:4352
    ds_read_b64_tr_b16 a[220:221], v4 offset:8448
    v_cvt_pk_bf16_f32 v74, v116, v117
    v_cvt_pk_bf16_f32 v90, v204, v205
    v_mfma_f32_16x16x32_bf16 v[20:23], a[64:67], a[32:35], 0
    v_exp_f32 v32, v32
    v_mfma_f32_16x16x32_bf16 v[20:23], a[68:71], a[36:39], v[20:23]
    ds_read_b64_tr_b16 a[222:223], v4 offset:12544
    ds_read_b64_tr_b16 a[224:225], v3 offset:512
    v_mfma_f32_16x16x32_bf16 v[20:23], a[72:75], a[40:43], v[20:23]
    v_exp_f32 v33, v33
    v_mfma_f32_16x16x32_bf16 v[20:23], a[76:79], a[44:47], v[20:23]
    v_cvt_pk_bf16_f32 v42, v32, v33
    s_add_u32 m0, s30, 49152
    v_lshlrev_b32 v118, 16, v75
    v_cvt_pk_bf16_f32 v91, v206, v207
    v_mfma_f32_16x16x32_bf16 v[24:27], a[80:83], a[32:35], 0
    v_exp_f32 v34, v34
    v_mfma_f32_16x16x32_bf16 v[24:27], a[84:87], a[36:39], v[24:27]
    buffer_load_dwordx4 v10, s[20:23], s29 offen offset:0 nt lds
    v_and_b32 v119, s34, v75
    v_mfma_f32_16x16x32_bf16 v[24:27], a[88:91], a[40:43], v[24:27]
    v_exp_f32 v35, v35
    v_mfma_f32_16x16x32_bf16 v[24:27], a[92:95], a[44:47], v[24:27]
    ds_read_b64_tr_b16 a[226:227], v3 offset:4608
    v_cvt_pk_bf16_f32 v43, v34, v35
    v_mul_f32 v118, s28, v118
    v_cvt_pk_bf16_f32 v98, v220, v221
    v_mfma_f32_16x16x32_bf16 v[28:31], a[96:99], a[32:35], 0
    v_exp_f32 v20, v20
    v_mfma_f32_16x16x32_bf16 v[28:31], a[100:103], a[36:39], v[28:31]
    ds_read_b64_tr_b16 a[228:229], v3 offset:8704
    ds_read_b64_tr_b16 a[230:231], v3 offset:12800
    v_mul_f32 v119, s28, v119
    v_mfma_f32_16x16x32_bf16 v[28:31], a[104:107], a[40:43], v[28:31]
    v_exp_f32 v21, v21
    v_mfma_f32_16x16x32_bf16 v[28:31], a[108:111], a[44:47], v[28:31]
    ds_read_b64_tr_b16 a[232:233], v4 offset:512
    v_cvt_pk_bf16_f32 v44, v20, v21
    v_cvt_pk_bf16_f32 v75, v118, v119
    v_cvt_pk_bf16_f32 v99, v222, v223
    v_mfma_f32_16x16x32_bf16 v[32:35], a[112:115], a[32:35], 0
    v_exp_f32 v22, v22
    v_mfma_f32_16x16x32_bf16 v[32:35], a[116:119], a[36:39], v[32:35]
    buffer_load_dwordx4 v11, s[20:23], s29 offen offset:1024 nt lds
    ds_write_b128 v15, v[72:75] offset:1024
    v_mfma_f32_16x16x32_bf16 v[32:35], a[120:123], a[40:43], v[32:35]
    v_exp_f32 v23, v23
    v_mfma_f32_16x16x32_bf16 v[32:35], a[124:127], a[44:47], v[32:35]
    ds_read_b64_tr_b16 a[234:235], v4 offset:4608
    v_cvt_pk_bf16_f32 v45, v22, v23
    ds_read_b128 a[48:51], v5 offset:12288
    v_add_f32 v120, v64, v65
    v_rcp_f32 v122, v120
    v_mfma_f32_16x16x32_bf16 v[160:163], a[128:131], v[36:39], 0
    v_exp_f32 v24, v24
    v_mfma_f32_16x16x32_bf16 v[160:163], a[132:135], v[40:43], v[160:163]
    ds_read_b64_tr_b16 a[236:237], v4 offset:8704
    ds_read_b64_tr_b16 a[238:239], v4 offset:12800
    ds_read_b128 a[52:55], v5 offset:12544
    s_waitcnt lgkmcnt(15)
    buffer_store_dwordx4 v[68:71], v6, s[24:27], s37 offen offset:0 nt
    v_subrev_u32 v120, s35, v120
    v_max_u32 v9, v9, v120
    v_mfma_f32_16x16x32_bf16 v[164:167], a[136:139], v[36:39], 0
    v_exp_f32 v25, v25
    v_mfma_f32_16x16x32_bf16 v[164:167], a[140:143], v[40:43], v[164:167]
    ds_read_b64_tr_b16 a[240:241], v3 offset:768
    v_cvt_pk_bf16_f32 v46, v24, v25
    ds_read_b128 a[56:59], v5 offset:12800
    v_mov_b32 v64, 0
    v_mov_b32 v65, 0
    v_mfma_f32_16x16x32_bf16 v[168:171], a[144:147], v[36:39], 0
    v_exp_f32 v26, v26
    v_mfma_f32_16x16x32_bf16 v[168:171], a[148:151], v[40:43], v[168:171]
    buffer_load_dwordx4 v12, s[20:23], s29 offen offset:2048 nt lds
    ds_read_b128 a[60:63], v5 offset:13056
    v_pk_mul_f32 v[224:225], v[224:225], v[122:123] op_sel_hi:[1,0]
    v_pk_mul_f32 v[226:227], v[226:227], v[122:123] op_sel_hi:[1,0]
    v_pk_mul_f32 v[240:241], v[240:241], v[122:123] op_sel_hi:[1,0]
    v_pk_mul_f32 v[242:243], v[242:243], v[122:123] op_sel_hi:[1,0]
PG3:
    s_cbranch_vccnz BODY
    v_pk_mul_f32 v[228:229], v[228:229], v[122:123] op_sel_hi:[1,0]
    v_pk_mul_f32 v[230:231], v[230:231], v[122:123] op_sel_hi:[1,0]
    v_pk_mul_f32 v[244:245], v[244:245], v[122:123] op_sel_hi:[1,0]
    v_pk_mul_f32 v[246:247], v[246:247], v[122:123] op_sel_hi:[1,0]
    v_pk_mul_f32 v[232:233], v[232:233], v[122:123] op_sel_hi:[1,0]
    v_pk_mul_f32 v[234:235], v[234:235], v[122:123] op_sel_hi:[1,0]
    v_pk_mul_f32 v[248:249], v[248:249], v[122:123] op_sel_hi:[1,0]
    v_pk_mul_f32 v[250:251], v[250:251], v[122:123] op_sel_hi:[1,0]
    v_pk_mul_f32 v[236:237], v[236:237], v[122:123] op_sel_hi:[1,0]
    v_pk_mul_f32 v[238:239], v[238:239], v[122:123] op_sel_hi:[1,0]
    v_pk_mul_f32 v[252:253], v[252:253], v[122:123] op_sel_hi:[1,0]
    v_pk_mul_f32 v[254:255], v[254:255], v[122:123] op_sel_hi:[1,0]
    v_mfma_f32_16x16x32_bf16 v[172:175], a[152:155], v[36:39], 0
    v_exp_f32 v27, v27
    v_mfma_f32_16x16x32_bf16 v[172:175], a[156:159], v[40:43], v[172:175]
    ds_read_b64_tr_b16 a[242:243], v3 offset:4864
    v_cvt_pk_bf16_f32 v47, v26, v27
    v_mfma_f32_16x16x32_bf16 v[176:179], a[160:163], v[36:39], 0
    v_exp_f32 v28, v28
    v_mfma_f32_16x16x32_bf16 v[176:179], a[164:167], v[40:43], v[176:179]
    ds_read_b64_tr_b16 a[244:245], v3 offset:8960
    ds_read_b64_tr_b16 a[246:247], v3 offset:13056
    v_mfma_f32_16x16x32_bf16 v[180:183], a[168:171], v[36:39], 0
    v_exp_f32 v29, v29
    v_mfma_f32_16x16x32_bf16 v[180:183], a[172:175], v[40:43], v[180:183]
    ds_read_b64_tr_b16 a[248:249], v4 offset:768
    v_cvt_pk_bf16_f32 v48, v28, v29
    v_cvt_pk_bf16_f32 v100, v224, v225
    v_mfma_f32_16x16x32_bf16 v[184:187], a[176:179], v[36:39], 0
    v_exp_f32 v30, v30
    v_mfma_f32_16x16x32_bf16 v[184:187], a[180:183], v[40:43], v[184:187]
    buffer_load_dwordx4 v13, s[20:23], s29 offen offset:3072 nt lds
    v_mfma_f32_16x16x32_bf16 v[188:191], a[184:187], v[36:39], 0
    v_exp_f32 v31, v31
    v_mfma_f32_16x16x32_bf16 v[188:191], a[188:191], v[40:43], v[188:191]
    ds_read_b64_tr_b16 a[250:251], v4 offset:4864
    v_cvt_pk_bf16_f32 v49, v30, v31
    v_smfmac_f32_16x16x64_bf16 v[56:59], v[16:19], v[36:43], v14
    ds_read_b64_tr_b16 a[252:253], v4 offset:8960
    ds_read_b64_tr_b16 a[254:255], v4 offset:13056
    s_waitcnt lgkmcnt(7)
    v_mfma_f32_16x16x32_bf16 v[20:23], a[64:67], a[48:51], 0
    v_exp_f32 v32, v32
    v_mfma_f32_16x16x32_bf16 v[20:23], a[68:71], a[52:55], v[20:23]
    ds_read_b128 a[64:67], v2 offset:0
    ds_read_b128 a[68:71], v2 offset:256
    v_mfma_f32_16x16x32_bf16 v[20:23], a[72:75], a[56:59], v[20:23]
    v_exp_f32 v33, v33
    v_mfma_f32_16x16x32_bf16 v[20:23], a[76:79], a[60:63], v[20:23]
    ds_read_b128 a[72:75], v2 offset:512
    v_cvt_pk_bf16_f32 v50, v32, v33
    v_cvt_pk_bf16_f32 v101, v226, v227
    v_mfma_f32_16x16x32_bf16 v[24:27], a[80:83], a[48:51], 0
    v_exp_f32 v34, v34
    v_mfma_f32_16x16x32_bf16 v[24:27], a[84:87], a[52:55], v[24:27]
    ds_read_b128 a[76:79], v2 offset:768
    s_add_u32 s29, s29, 16384
    v_mfma_f32_16x16x32_bf16 v[24:27], a[88:91], a[56:59], v[24:27]
    v_exp_f32 v35, v35
    v_mfma_f32_16x16x32_bf16 v[24:27], a[92:95], a[60:63], v[24:27]
    ds_read_b128 a[80:83], v2 offset:4096
    v_cvt_pk_bf16_f32 v51, v34, v35
    v_mfma_f32_16x16x32_bf16 v[28:31], a[96:99], a[48:51], 0
    v_exp_f32 v20, v20
    v_mfma_f32_16x16x32_bf16 v[28:31], a[100:103], a[52:55], v[28:31]
    ds_read_b128 a[84:87], v2 offset:4352
    s_add_u32 s30, s30, s32
    v_mfma_f32_16x16x32_bf16 v[28:31], a[104:107], a[56:59], v[28:31]
    v_exp_f32 v21, v21
    v_mfma_f32_16x16x32_bf16 v[28:31], a[108:111], a[60:63], v[28:31]
    ds_read_b128 a[88:91], v2 offset:4608
    v_cvt_pk_bf16_f32 v36, v20, v21
    v_mfma_f32_16x16x32_bf16 v[32:35], a[112:115], a[48:51], 0
    v_exp_f32 v22, v22
    v_mfma_f32_16x16x32_bf16 v[32:35], a[116:119], a[52:55], v[32:35]
    ds_read_b128 a[92:95], v2 offset:4864
    v_cvt_pk_bf16_f32 v108, v240, v241
    v_cvt_pk_bf16_f32 v109, v242, v243
    v_mfma_f32_16x16x32_bf16 v[32:35], a[120:123], a[56:59], v[32:35]
    v_exp_f32 v23, v23
    v_mfma_f32_16x16x32_bf16 v[32:35], a[124:127], a[60:63], v[32:35]
    ds_read_b128 a[96:99], v2 offset:8192
    v_cvt_pk_bf16_f32 v37, v22, v23
    v_mfma_f32_16x16x32_bf16 v[192:195], a[128:131], v[44:47], 0
    v_exp_f32 v24, v24
    v_mfma_f32_16x16x32_bf16 v[192:195], a[132:135], v[48:51], v[192:195]
    ds_read_b128 a[100:103], v2 offset:8448
    ds_read_b128 v[72:75], v81 offset:512
    v_add_u32 v81, 1024, v81
    v_mfma_f32_16x16x32_bf16 v[196:199], a[136:139], v[44:47], 0
    v_exp_f32 v25, v25
    v_mfma_f32_16x16x32_bf16 v[196:199], a[140:143], v[48:51], v[196:199]
    ds_read_b128 a[104:107], v2 offset:8704
    v_cvt_pk_bf16_f32 v38, v24, v25
    v_mfma_f32_16x16x32_bf16 v[200:203], a[144:147], v[44:47], 0
    v_exp_f32 v26, v26
    v_mfma_f32_16x16x32_bf16 v[200:203], a[148:151], v[48:51], v[200:203]
    ds_read_b128 a[108:111], v2 offset:8960
    v_cvt_pk_bf16_f32 v102, v228, v229
    v_cvt_pk_bf16_f32 v103, v230, v231
    v_mfma_f32_16x16x32_bf16 v[204:207], a[152:155], v[44:47], 0
    v_exp_f32 v27, v27
    v_mfma_f32_16x16x32_bf16 v[204:207], a[156:159], v[48:51], v[204:207]
    ds_read_b128 a[112:115], v2 offset:12288
    v_cvt_pk_bf16_f32 v39, v26, v27
    v_mfma_f32_16x16x32_bf16 v[208:211], a[160:163], v[44:47], 0
    v_exp_f32 v28, v28
    v_mfma_f32_16x16x32_bf16 v[208:211], a[164:167], v[48:51], v[208:211]
    ds_read_b128 a[116:119], v2 offset:12544
    s_waitcnt lgkmcnt(4)
    buffer_store_dwordx4 v[72:75], v6, s[24:27], s37 offen offset:1024 nt
    v_mfma_f32_16x16x32_bf16 v[212:215], a[168:171], v[44:47], 0
    v_exp_f32 v29, v29
    v_mfma_f32_16x16x32_bf16 v[212:215], a[172:175], v[48:51], v[212:215]
    ds_read_b128 a[120:123], v2 offset:12800
    v_cvt_pk_bf16_f32 v40, v28, v29
    s_add_u32 s37, s37, 2048
    v_mfma_f32_16x16x32_bf16 v[216:219], a[176:179], v[44:47], 0
    v_exp_f32 v30, v30
    v_mfma_f32_16x16x32_bf16 v[216:219], a[180:183], v[48:51], v[216:219]
    ds_read_b128 a[124:127], v2 offset:13056
    v_cvt_pk_bf16_f32 v110, v244, v245
    v_mfma_f32_16x16x32_bf16 v[220:223], a[184:187], v[44:47], 0
    v_exp_f32 v31, v31
    v_mfma_f32_16x16x32_bf16 v[220:223], a[188:191], v[48:51], v[220:223]
    v_cvt_pk_bf16_f32 v41, v30, v31
    v_cvt_pk_bf16_f32 v111, v246, v247
    v_cvt_pk_bf16_f32 v104, v232, v233
    v_smfmac_f32_16x16x64_bf16 v[60:63], v[16:19], v[44:51], v14
    s_waitcnt lgkmcnt(4)
    v_cvt_pk_bf16_f32 v105, v234, v235
    v_mfma_f32_16x16x32_bf16 v[20:23], a[64:67], a[0:3], 0
    v_exp_f32 v32, v32
    v_mfma_f32_16x16x32_bf16 v[20:23], a[68:71], a[4:7], v[20:23]
    ds_write2st64_b64 v76, v[84:85], v[92:93] offset0:8 offset1:24
    v_cvt_pk_bf16_f32 v112, v248, v249
    v_mfma_f32_16x16x32_bf16 v[20:23], a[72:75], a[8:11], v[20:23]
    v_exp_f32 v33, v33
    v_mfma_f32_16x16x32_bf16 v[20:23], a[76:79], a[12:15], v[20:23]
    ds_write2st64_b64 v77, v[86:87], v[94:95] offset0:8 offset1:24
    v_cvt_pk_bf16_f32 v42, v32, v33
    v_mfma_f32_16x16x32_bf16 v[24:27], a[80:83], a[0:3], 0
    v_exp_f32 v34, v34
    v_mfma_f32_16x16x32_bf16 v[24:27], a[84:87], a[4:7], v[24:27]
    v_cvt_pk_bf16_f32 v113, v250, v251
    v_cvt_pk_bf16_f32 v106, v236, v237
    v_mfma_f32_16x16x32_bf16 v[24:27], a[88:91], a[8:11], v[24:27]
    v_exp_f32 v35, v35
    v_mfma_f32_16x16x32_bf16 v[24:27], a[92:95], a[12:15], v[24:27]
    ds_write2st64_b64 v78, v[88:89], v[96:97] offset0:8 offset1:24
    v_cvt_pk_bf16_f32 v43, v34, v35
    v_cvt_pk_bf16_f32 v107, v238, v239
    v_mfma_f32_16x16x32_bf16 v[28:31], a[96:99], a[0:3], 0
    v_exp_f32 v20, v20
    v_mfma_f32_16x16x32_bf16 v[28:31], a[100:103], a[4:7], v[28:31]
    v_cvt_pk_bf16_f32 v114, v252, v253
    v_cvt_pk_bf16_f32 v115, v254, v255
    v_mfma_f32_16x16x32_bf16 v[28:31], a[104:107], a[8:11], v[28:31]
    v_exp_f32 v21, v21
    v_mfma_f32_16x16x32_bf16 v[28:31], a[108:111], a[12:15], v[28:31]
    ds_write2st64_b64 v79, v[90:91], v[98:99] offset0:8 offset1:24
    v_cvt_pk_bf16_f32 v44, v20, v21
    s_waitcnt lgkmcnt(4)
    v_mfma_f32_16x16x32_bf16 v[32:35], a[112:115], a[0:3], 0
    v_exp_f32 v22, v22
    v_mfma_f32_16x16x32_bf16 v[32:35], a[116:119], a[4:7], v[32:35]
    v_mfma_f32_16x16x32_bf16 v[32:35], a[120:123], a[8:11], v[32:35]
    v_exp_f32 v23, v23
    v_mfma_f32_16x16x32_bf16 v[32:35], a[124:127], a[12:15], v[32:35]
    v_cvt_pk_bf16_f32 v45, v22, v23
    v_mfma_f32_16x16x32_bf16 v[224:227], a[128:131], v[36:39], 0
    v_exp_f32 v24, v24
    v_mfma_f32_16x16x32_bf16 v[224:227], a[132:135], v[40:43], v[224:227]
    ds_write2st64_b64 v76, v[100:101], v[108:109] offset0:12 offset1:28
    v_mfma_f32_16x16x32_bf16 v[228:231], a[136:139], v[36:39], 0
    v_exp_f32 v25, v25
    v_mfma_f32_16x16x32_bf16 v[228:231], a[140:143], v[40:43], v[228:231]
    v_cvt_pk_bf16_f32 v46, v24, v25
    v_mfma_f32_16x16x32_bf16 v[232:235], a[144:147], v[36:39], 0
    v_exp_f32 v26, v26
    v_mfma_f32_16x16x32_bf16 v[232:235], a[148:151], v[40:43], v[232:235]
    ds_write2st64_b64 v77, v[102:103], v[110:111] offset0:12 offset1:28
    v_mfma_f32_16x16x32_bf16 v[236:239], a[152:155], v[36:39], 0
    v_exp_f32 v27, v27
    v_mfma_f32_16x16x32_bf16 v[236:239], a[156:159], v[40:43], v[236:239]
    v_cvt_pk_bf16_f32 v47, v26, v27
    v_mfma_f32_16x16x32_bf16 v[240:243], a[160:163], v[36:39], 0
    v_exp_f32 v28, v28
    v_mfma_f32_16x16x32_bf16 v[240:243], a[164:167], v[40:43], v[240:243]
    ds_write2st64_b64 v78, v[104:105], v[112:113] offset0:12 offset1:28
    s_cmp_eq_u32 s30, s31
    s_cselect_b32 s32, 0xffff8000, s38
    v_mfma_f32_16x16x32_bf16 v[244:247], a[168:171], v[36:39], 0
    v_exp_f32 v29, v29
    v_mfma_f32_16x16x32_bf16 v[244:247], a[172:175], v[40:43], v[244:247]
    v_cvt_pk_bf16_f32 v48, v28, v29
    v_add_u32 v3, s32, v3
    v_mfma_f32_16x16x32_bf16 v[248:251], a[176:179], v[36:39], 0
    v_exp_f32 v30, v30
    v_mfma_f32_16x16x32_bf16 v[248:251], a[180:183], v[40:43], v[248:251]
    ds_write2st64_b64 v79, v[106:107], v[114:115] offset0:12 offset1:28
    v_add_u32 v4, s32, v4
    v_add_u32 v2, s32, v2
    v_mfma_f32_16x16x32_bf16 v[252:255], a[184:187], v[36:39], 0
    v_exp_f32 v31, v31
    v_mfma_f32_16x16x32_bf16 v[252:255], a[188:191], v[40:43], v[252:255]
    v_cvt_pk_bf16_f32 v49, v30, v31
    v_smfmac_f32_16x16x64_bf16 v[64:67], v[16:19], v[36:43], v14
LOOPS:
    v_mfma_f32_16x16x32_bf16 v[20:23], a[64:67], a[16:19], 0
    v_exp_f32 v32, v32
    v_mfma_f32_16x16x32_bf16 v[20:23], a[68:71], a[20:23], v[20:23]
    s_waitcnt vmcnt(10) lgkmcnt(0)
    s_barrier
    v_mfma_f32_16x16x32_bf16 v[20:23], a[72:75], a[24:27], v[20:23]
    v_exp_f32 v33, v33
    v_mfma_f32_16x16x32_bf16 v[20:23], a[76:79], a[28:31], v[20:23]
    v_cvt_pk_bf16_f32 v50, v32, v33
    s_mov_b32 m0, s30
    v_mfma_f32_16x16x32_bf16 v[24:27], a[80:83], a[16:19], 0
    v_exp_f32 v34, v34
    v_mfma_f32_16x16x32_bf16 v[24:27], a[84:87], a[20:23], v[24:27]
    buffer_load_dwordx4 v10, s[16:19], s29 offen offset:0 nt lds
    v_mfma_f32_16x16x32_bf16 v[24:27], a[88:91], a[24:27], v[24:27]
    v_exp_f32 v35, v35
    v_mfma_f32_16x16x32_bf16 v[24:27], a[92:95], a[28:31], v[24:27]
    ds_read_b64_tr_b16 a[128:129], v3 offset:0
    v_cvt_pk_bf16_f32 v51, v34, v35
    v_mfma_f32_16x16x32_bf16 v[28:31], a[96:99], a[16:19], 0
    v_exp_f32 v20, v20
    v_mfma_f32_16x16x32_bf16 v[28:31], a[100:103], a[20:23], v[28:31]
    ds_read_b64_tr_b16 a[130:131], v3 offset:4096
    v_mfma_f32_16x16x32_bf16 v[28:31], a[104:107], a[24:27], v[28:31]
    v_exp_f32 v21, v21
    v_mfma_f32_16x16x32_bf16 v[28:31], a[108:111], a[28:31], v[28:31]
    ds_read_b64_tr_b16 a[132:133], v3 offset:8192
    v_cvt_pk_bf16_f32 v36, v20, v21
    v_mfma_f32_16x16x32_bf16 v[32:35], a[112:115], a[16:19], 0
    v_exp_f32 v22, v22
    v_mfma_f32_16x16x32_bf16 v[32:35], a[116:119], a[20:23], v[32:35]
    buffer_load_dwordx4 v11, s[16:19], s29 offen offset:1024 nt lds
    v_mfma_f32_16x16x32_bf16 v[32:35], a[120:123], a[24:27], v[32:35]
    v_exp_f32 v23, v23
    v_mfma_f32_16x16x32_bf16 v[32:35], a[124:127], a[28:31], v[32:35]
    ds_read_b64_tr_b16 a[134:135], v3 offset:12288
    v_cvt_pk_bf16_f32 v37, v22, v23
    v_mfma_f32_16x16x32_bf16 v[128:131], a[192:195], v[44:47], v[128:131]
    v_exp_f32 v24, v24
    v_mfma_f32_16x16x32_bf16 v[128:131], a[196:199], v[48:51], v[128:131]
    ds_read_b64_tr_b16 a[136:137], v4 offset:0
    v_mfma_f32_16x16x32_bf16 v[132:135], a[200:203], v[44:47], v[132:135]
    v_exp_f32 v25, v25
    v_mfma_f32_16x16x32_bf16 v[132:135], a[204:207], v[48:51], v[132:135]
    ds_read_b64_tr_b16 a[138:139], v4 offset:4096
    v_cvt_pk_bf16_f32 v38, v24, v25
    v_mfma_f32_16x16x32_bf16 v[136:139], a[208:211], v[44:47], v[136:139]
    v_exp_f32 v26, v26
    v_mfma_f32_16x16x32_bf16 v[136:139], a[212:215], v[48:51], v[136:139]
    buffer_load_dwordx4 v12, s[16:19], s29 offen offset:2048 nt lds
    v_mfma_f32_16x16x32_bf16 v[140:143], a[216:219], v[44:47], v[140:143]
    v_exp_f32 v27, v27
    v_mfma_f32_16x16x32_bf16 v[140:143], a[220:223], v[48:51], v[140:143]
    ds_read_b64_tr_b16 a[140:141], v4 offset:8192
    v_cvt_pk_bf16_f32 v39, v26, v27
    v_mfma_f32_16x16x32_bf16 v[144:147], a[224:227], v[44:47], v[144:147]
    v_exp_f32 v28, v28
    v_mfma_f32_16x16x32_bf16 v[144:147], a[228:231], v[48:51], v[144:147]
    ds_read_b64_tr_b16 a[142:143], v4 offset:12288
    v_mfma_f32_16x16x32_bf16 v[148:151], a[232:235], v[44:47], v[148:151]
    v_exp_f32 v29, v29
    v_mfma_f32_16x16x32_bf16 v[148:151], a[236:239], v[48:51], v[148:151]
    ds_read_b64_tr_b16 a[144:145], v3 offset:256
    v_cvt_pk_bf16_f32 v40, v28, v29
    v_mfma_f32_16x16x32_bf16 v[152:155], a[240:243], v[44:47], v[152:155]
    v_exp_f32 v30, v30
    v_mfma_f32_16x16x32_bf16 v[152:155], a[244:247], v[48:51], v[152:155]
    buffer_load_dwordx4 v13, s[16:19], s29 offen offset:3072 nt lds
    v_mfma_f32_16x16x32_bf16 v[156:159], a[248:251], v[44:47], v[156:159]
    v_exp_f32 v31, v31
    v_mfma_f32_16x16x32_bf16 v[156:159], a[252:255], v[48:51], v[156:159]
    ds_read_b64_tr_b16 a[146:147], v3 offset:4352
    v_cvt_pk_bf16_f32 v41, v30, v31
    v_smfmac_f32_16x16x64_bf16 v[52:55], v[16:19], v[44:51], v14
    ds_read_b64_tr_b16 a[148:149], v3 offset:8448
    v_mfma_f32_16x16x32_bf16 v[20:23], a[64:67], a[32:35], 0
    v_exp_f32 v32, v32
    v_mfma_f32_16x16x32_bf16 v[20:23], a[68:71], a[36:39], v[20:23]
    ds_read_b64_tr_b16 a[150:151], v3 offset:12544
    v_mfma_f32_16x16x32_bf16 v[20:23], a[72:75], a[40:43], v[20:23]
    v_exp_f32 v33, v33
    v_mfma_f32_16x16x32_bf16 v[20:23], a[76:79], a[44:47], v[20:23]
    v_cvt_pk_bf16_f32 v42, v32, v33
    s_add_u32 m0, s30, 49152
    v_mfma_f32_16x16x32_bf16 v[24:27], a[80:83], a[32:35], 0
    v_exp_f32 v34, v34
    v_mfma_f32_16x16x32_bf16 v[24:27], a[84:87], a[36:39], v[24:27]
    buffer_load_dwordx4 v10, s[20:23], s29 offen offset:0 nt lds
    v_mfma_f32_16x16x32_bf16 v[24:27], a[88:91], a[40:43], v[24:27]
    v_exp_f32 v35, v35
    v_mfma_f32_16x16x32_bf16 v[24:27], a[92:95], a[44:47], v[24:27]
    ds_read_b64_tr_b16 a[152:153], v4 offset:256
    v_cvt_pk_bf16_f32 v43, v34, v35
    v_mfma_f32_16x16x32_bf16 v[28:31], a[96:99], a[32:35], 0
    v_exp_f32 v20, v20
    v_mfma_f32_16x16x32_bf16 v[28:31], a[100:103], a[36:39], v[28:31]
    ds_read_b64_tr_b16 a[154:155], v4 offset:4352
    v_mfma_f32_16x16x32_bf16 v[28:31], a[104:107], a[40:43], v[28:31]
    v_exp_f32 v21, v21
    v_mfma_f32_16x16x32_bf16 v[28:31], a[108:111], a[44:47], v[28:31]
    ds_read_b64_tr_b16 a[156:157], v4 offset:8448
    v_cvt_pk_bf16_f32 v44, v20, v21
    v_mfma_f32_16x16x32_bf16 v[32:35], a[112:115], a[32:35], 0
    v_exp_f32 v22, v22
    v_mfma_f32_16x16x32_bf16 v[32:35], a[116:119], a[36:39], v[32:35]
    buffer_load_dwordx4 v11, s[20:23], s29 offen offset:1024 nt lds
    v_mfma_f32_16x16x32_bf16 v[32:35], a[120:123], a[40:43], v[32:35]
    v_exp_f32 v23, v23
    v_mfma_f32_16x16x32_bf16 v[32:35], a[124:127], a[44:47], v[32:35]
    ds_read_b64_tr_b16 a[158:159], v4 offset:12544
    v_cvt_pk_bf16_f32 v45, v22, v23
    v_mfma_f32_16x16x32_bf16 v[160:163], a[192:195], v[36:39], v[160:163]
    v_exp_f32 v24, v24
    v_mfma_f32_16x16x32_bf16 v[160:163], a[196:199], v[40:43], v[160:163]
    ds_read_b64_tr_b16 a[160:161], v3 offset:512
    v_mfma_f32_16x16x32_bf16 v[164:167], a[200:203], v[36:39], v[164:167]
    v_exp_f32 v25, v25
    v_mfma_f32_16x16x32_bf16 v[164:167], a[204:207], v[40:43], v[164:167]
    ds_read_b64_tr_b16 a[162:163], v3 offset:4608
    v_cvt_pk_bf16_f32 v46, v24, v25
    v_mfma_f32_16x16x32_bf16 v[168:171], a[208:211], v[36:39], v[168:171]
    v_exp_f32 v26, v26
    v_mfma_f32_16x16x32_bf16 v[168:171], a[212:215], v[40:43], v[168:171]
    buffer_load_dwordx4 v12, s[20:23], s29 offen offset:2048 nt lds
    v_mfma_f32_16x16x32_bf16 v[172:175], a[216:219], v[36:39], v[172:175]
    v_exp_f32 v27, v27
    v_mfma_f32_16x16x32_bf16 v[172:175], a[220:223], v[40:43], v[172:175]
    ds_read_b64_tr_b16 a[164:165], v3 offset:8704
    v_cvt_pk_bf16_f32 v47, v26, v27
    v_mfma_f32_16x16x32_bf16 v[176:179], a[224:227], v[36:39], v[176:179]
    v_exp_f32 v28, v28
    v_mfma_f32_16x16x32_bf16 v[176:179], a[228:231], v[40:43], v[176:179]
    ds_read_b64_tr_b16 a[166:167], v3 offset:12800
    v_mfma_f32_16x16x32_bf16 v[180:183], a[232:235], v[36:39], v[180:183]
    v_exp_f32 v29, v29
    v_mfma_f32_16x16x32_bf16 v[180:183], a[236:239], v[40:43], v[180:183]
    ds_read_b64_tr_b16 a[168:169], v4 offset:512
    v_cvt_pk_bf16_f32 v48, v28, v29
    v_mfma_f32_16x16x32_bf16 v[184:187], a[240:243], v[36:39], v[184:187]
    v_exp_f32 v30, v30
    v_mfma_f32_16x16x32_bf16 v[184:187], a[244:247], v[40:43], v[184:187]
    buffer_load_dwordx4 v13, s[20:23], s29 offen offset:3072 nt lds
    v_mfma_f32_16x16x32_bf16 v[188:191], a[248:251], v[36:39], v[188:191]
    v_exp_f32 v31, v31
    v_mfma_f32_16x16x32_bf16 v[188:191], a[252:255], v[40:43], v[188:191]
    ds_read_b64_tr_b16 a[170:171], v4 offset:4608
    v_cvt_pk_bf16_f32 v49, v30, v31
    v_smfmac_f32_16x16x64_bf16 v[56:59], v[16:19], v[36:43], v14
    ds_read_b64_tr_b16 a[172:173], v4 offset:8704
    s_add_u32 s29, s29, 16384
    v_mfma_f32_16x16x32_bf16 v[20:23], a[64:67], a[48:51], 0
    v_exp_f32 v32, v32
    v_mfma_f32_16x16x32_bf16 v[20:23], a[68:71], a[52:55], v[20:23]
    ds_read_b128 a[64:67], v2 offset:0
    ds_read_b128 a[68:71], v2 offset:256
    v_mfma_f32_16x16x32_bf16 v[20:23], a[72:75], a[56:59], v[20:23]
    v_exp_f32 v33, v33
    v_mfma_f32_16x16x32_bf16 v[20:23], a[76:79], a[60:63], v[20:23]
    ds_read_b128 a[72:75], v2 offset:512
    v_cvt_pk_bf16_f32 v50, v32, v33
    v_mfma_f32_16x16x32_bf16 v[24:27], a[80:83], a[48:51], 0
    v_exp_f32 v34, v34
    v_mfma_f32_16x16x32_bf16 v[24:27], a[84:87], a[52:55], v[24:27]
    ds_read_b128 a[76:79], v2 offset:768
    s_add_u32 s30, s30, s32
    v_mfma_f32_16x16x32_bf16 v[24:27], a[88:91], a[56:59], v[24:27]
    v_exp_f32 v35, v35
    v_mfma_f32_16x16x32_bf16 v[24:27], a[92:95], a[60:63], v[24:27]
    ds_read_b128 a[80:83], v2 offset:4096
    v_cvt_pk_bf16_f32 v51, v34, v35
    v_mfma_f32_16x16x32_bf16 v[28:31], a[96:99], a[48:51], 0
    v_exp_f32 v20, v20
    v_mfma_f32_16x16x32_bf16 v[28:31], a[100:103], a[52:55], v[28:31]
    ds_read_b128 a[84:87], v2 offset:4352
    v_mfma_f32_16x16x32_bf16 v[28:31], a[104:107], a[56:59], v[28:31]
    v_exp_f32 v21, v21
    v_mfma_f32_16x16x32_bf16 v[28:31], a[108:111], a[60:63], v[28:31]
    ds_read_b128 a[88:91], v2 offset:4608
    v_cvt_pk_bf16_f32 v36, v20, v21
    v_mfma_f32_16x16x32_bf16 v[32:35], a[112:115], a[48:51], 0
    v_exp_f32 v22, v22
    v_mfma_f32_16x16x32_bf16 v[32:35], a[116:119], a[52:55], v[32:35]
    ds_read_b128 a[92:95], v2 offset:4864
    v_mfma_f32_16x16x32_bf16 v[32:35], a[120:123], a[56:59], v[32:35]
    v_exp_f32 v23, v23
    v_mfma_f32_16x16x32_bf16 v[32:35], a[124:127], a[60:63], v[32:35]
    ds_read_b128 a[96:99], v2 offset:8192
    v_cvt_pk_bf16_f32 v37, v22, v23
    v_mfma_f32_16x16x32_bf16 v[192:195], a[192:195], v[44:47], v[192:195]
    v_exp_f32 v24, v24
    v_mfma_f32_16x16x32_bf16 v[192:195], a[196:199], v[48:51], v[192:195]
    ds_read_b128 a[100:103], v2 offset:8448
    v_mfma_f32_16x16x32_bf16 v[196:199], a[200:203], v[44:47], v[196:199]
    v_exp_f32 v25, v25
    v_mfma_f32_16x16x32_bf16 v[196:199], a[204:207], v[48:51], v[196:199]
    ds_read_b128 a[104:107], v2 offset:8704
    v_cvt_pk_bf16_f32 v38, v24, v25
    v_mfma_f32_16x16x32_bf16 v[200:203], a[208:211], v[44:47], v[200:203]
    v_exp_f32 v26, v26
    v_mfma_f32_16x16x32_bf16 v[200:203], a[212:215], v[48:51], v[200:203]
    ds_read_b128 a[108:111], v2 offset:8960
    v_mfma_f32_16x16x32_bf16 v[204:207], a[216:219], v[44:47], v[204:207]
    v_exp_f32 v27, v27
    v_mfma_f32_16x16x32_bf16 v[204:207], a[220:223], v[48:51], v[204:207]
    ds_read_b128 a[112:115], v2 offset:12288
    v_cvt_pk_bf16_f32 v39, v26, v27
    v_mfma_f32_16x16x32_bf16 v[208:211], a[224:227], v[44:47], v[208:211]
    v_exp_f32 v28, v28
    v_mfma_f32_16x16x32_bf16 v[208:211], a[228:231], v[48:51], v[208:211]
    ds_read_b128 a[116:119], v2 offset:12544
    v_mfma_f32_16x16x32_bf16 v[212:215], a[232:235], v[44:47], v[212:215]
    v_exp_f32 v29, v29
    v_mfma_f32_16x16x32_bf16 v[212:215], a[236:239], v[48:51], v[212:215]
    ds_read_b128 a[120:123], v2 offset:12800
    v_cvt_pk_bf16_f32 v40, v28, v29
    v_mfma_f32_16x16x32_bf16 v[216:219], a[240:243], v[44:47], v[216:219]
    v_exp_f32 v30, v30
    v_mfma_f32_16x16x32_bf16 v[216:219], a[244:247], v[48:51], v[216:219]
    ds_read_b128 a[124:127], v2 offset:13056
    v_mfma_f32_16x16x32_bf16 v[220:223], a[248:251], v[44:47], v[220:223]
    v_exp_f32 v31, v31
    v_mfma_f32_16x16x32_bf16 v[220:223], a[252:255], v[48:51], v[220:223]
    v_cvt_pk_bf16_f32 v41, v30, v31
    ds_read_b128 v[68:71], v80 offset:0
    v_smfmac_f32_16x16x64_bf16 v[60:63], v[16:19], v[44:51], v14
    s_waitcnt lgkmcnt(5)
    v_add_u32 v80, 1024, v80
    v_mfma_f32_16x16x32_bf16 v[20:23], a[64:67], a[0:3], 0
    v_exp_f32 v32, v32
    v_mfma_f32_16x16x32_bf16 v[20:23], a[68:71], a[4:7], v[20:23]
    ds_read_b64_tr_b16 a[174:175], v4 offset:12800
    v_mfma_f32_16x16x32_bf16 v[20:23], a[72:75], a[8:11], v[20:23]
    v_exp_f32 v33, v33
    v_mfma_f32_16x16x32_bf16 v[20:23], a[76:79], a[12:15], v[20:23]
    ds_read_b64_tr_b16 a[176:177], v3 offset:768
    v_cvt_pk_bf16_f32 v42, v32, v33
    v_mfma_f32_16x16x32_bf16 v[24:27], a[80:83], a[0:3], 0
    v_exp_f32 v34, v34
    v_mfma_f32_16x16x32_bf16 v[24:27], a[84:87], a[4:7], v[24:27]
    ds_read_b64_tr_b16 a[178:179], v3 offset:4864
    v_mfma_f32_16x16x32_bf16 v[24:27], a[88:91], a[8:11], v[24:27]
    v_exp_f32 v35, v35
    v_mfma_f32_16x16x32_bf16 v[24:27], a[92:95], a[12:15], v[24:27]
    ds_read_b64_tr_b16 a[180:181], v3 offset:8960
    v_cvt_pk_bf16_f32 v43, v34, v35
    v_mfma_f32_16x16x32_bf16 v[28:31], a[96:99], a[0:3], 0
    v_exp_f32 v20, v20
    v_mfma_f32_16x16x32_bf16 v[28:31], a[100:103], a[4:7], v[28:31]
    ds_read_b64_tr_b16 a[182:183], v3 offset:13056
    v_mfma_f32_16x16x32_bf16 v[28:31], a[104:107], a[8:11], v[28:31]
    v_exp_f32 v21, v21
    v_mfma_f32_16x16x32_bf16 v[28:31], a[108:111], a[12:15], v[28:31]
    v_cvt_pk_bf16_f32 v44, v20, v21
    s_waitcnt lgkmcnt(6)
    v_mfma_f32_16x16x32_bf16 v[32:35], a[112:115], a[0:3], 0
    v_exp_f32 v22, v22
    v_mfma_f32_16x16x32_bf16 v[32:35], a[116:119], a[4:7], v[32:35]
    ds_read_b64_tr_b16 a[184:185], v4 offset:768
    v_mfma_f32_16x16x32_bf16 v[32:35], a[120:123], a[8:11], v[32:35]
    v_exp_f32 v23, v23
    v_mfma_f32_16x16x32_bf16 v[32:35], a[124:127], a[12:15], v[32:35]
    ds_read_b64_tr_b16 a[186:187], v4 offset:4864
    v_cvt_pk_bf16_f32 v45, v22, v23
    v_mfma_f32_16x16x32_bf16 v[224:227], a[192:195], v[36:39], v[224:227]
    v_exp_f32 v24, v24
    v_mfma_f32_16x16x32_bf16 v[224:227], a[196:199], v[40:43], v[224:227]
    ds_read_b64_tr_b16 a[188:189], v4 offset:8960
    v_mfma_f32_16x16x32_bf16 v[228:231], a[200:203], v[36:39], v[228:231]
    v_exp_f32 v25, v25
    v_mfma_f32_16x16x32_bf16 v[228:231], a[204:207], v[40:43], v[228:231]
    ds_read_b64_tr_b16 a[190:191], v4 offset:13056
    v_cvt_pk_bf16_f32 v46, v24, v25
    v_mfma_f32_16x16x32_bf16 v[232:235], a[208:211], v[36:39], v[232:235]
    v_exp_f32 v26, v26
    v_mfma_f32_16x16x32_bf16 v[232:235], a[212:215], v[40:43], v[232:235]
    s_waitcnt lgkmcnt(9)
    buffer_store_dwordx4 v[68:71], v6, s[24:27], s37 offen offset:0 nt
    v_mfma_f32_16x16x32_bf16 v[236:239], a[216:219], v[36:39], v[236:239]
    v_exp_f32 v27, v27
    v_mfma_f32_16x16x32_bf16 v[236:239], a[220:223], v[40:43], v[236:239]
    v_cvt_pk_bf16_f32 v47, v26, v27
    v_mfma_f32_16x16x32_bf16 v[240:243], a[224:227], v[36:39], v[240:243]
    v_exp_f32 v28, v28
    v_mfma_f32_16x16x32_bf16 v[240:243], a[228:231], v[40:43], v[240:243]
    s_cmp_eq_u32 s30, s31
    s_cselect_b32 s32, 0xffff8000, s38
    v_mfma_f32_16x16x32_bf16 v[244:247], a[232:235], v[36:39], v[244:247]
    v_exp_f32 v29, v29
    v_mfma_f32_16x16x32_bf16 v[244:247], a[236:239], v[40:43], v[244:247]
    v_cvt_pk_bf16_f32 v48, v28, v29
    v_add_u32 v3, s32, v3
    v_mfma_f32_16x16x32_bf16 v[248:251], a[240:243], v[36:39], v[248:251]
    v_exp_f32 v30, v30
    v_mfma_f32_16x16x32_bf16 v[248:251], a[244:247], v[40:43], v[248:251]
    v_add_u32 v4, s32, v4
    v_add_u32 v2, s32, v2
    v_mfma_f32_16x16x32_bf16 v[252:255], a[248:251], v[36:39], v[252:255]
    v_exp_f32 v31, v31
    v_mfma_f32_16x16x32_bf16 v[252:255], a[252:255], v[40:43], v[252:255]
    v_cvt_pk_bf16_f32 v49, v30, v31
    s_cmp_eq_u32 s29, 540672
    v_smfmac_f32_16x16x64_bf16 v[64:67], v[16:19], v[36:43], v14
    s_cbranch_scc1 T31
    v_mfma_f32_16x16x32_bf16 v[20:23], a[64:67], a[16:19], 0
    v_exp_f32 v32, v32
    v_mfma_f32_16x16x32_bf16 v[20:23], a[68:71], a[20:23], v[20:23]
    s_waitcnt vmcnt(10) lgkmcnt(0)
    s_barrier
    v_mfma_f32_16x16x32_bf16 v[20:23], a[72:75], a[24:27], v[20:23]
    v_exp_f32 v33, v33
    v_mfma_f32_16x16x32_bf16 v[20:23], a[76:79], a[28:31], v[20:23]
    v_cvt_pk_bf16_f32 v50, v32, v33
    s_mov_b32 m0, s30
    v_mfma_f32_16x16x32_bf16 v[24:27], a[80:83], a[16:19], 0
    v_exp_f32 v34, v34
    v_mfma_f32_16x16x32_bf16 v[24:27], a[84:87], a[20:23], v[24:27]
    buffer_load_dwordx4 v10, s[16:19], s29 offen offset:0 nt lds
    v_mfma_f32_16x16x32_bf16 v[24:27], a[88:91], a[24:27], v[24:27]
    v_exp_f32 v35, v35
    v_mfma_f32_16x16x32_bf16 v[24:27], a[92:95], a[28:31], v[24:27]
    ds_read_b64_tr_b16 a[192:193], v3 offset:0
    v_cvt_pk_bf16_f32 v51, v34, v35
    v_mfma_f32_16x16x32_bf16 v[28:31], a[96:99], a[16:19], 0
    v_exp_f32 v20, v20
    v_mfma_f32_16x16x32_bf16 v[28:31], a[100:103], a[20:23], v[28:31]
    ds_read_b64_tr_b16 a[194:195], v3 offset:4096
    v_mfma_f32_16x16x32_bf16 v[28:31], a[104:107], a[24:27], v[28:31]
    v_exp_f32 v21, v21
    v_mfma_f32_16x16x32_bf16 v[28:31], a[108:111], a[28:31], v[28:31]
    ds_read_b64_tr_b16 a[196:197], v3 offset:8192
    v_cvt_pk_bf16_f32 v36, v20, v21
    v_mfma_f32_16x16x32_bf16 v[32:35], a[112:115], a[16:19], 0
    v_exp_f32 v22, v22
    v_mfma_f32_16x16x32_bf16 v[32:35], a[116:119], a[20:23], v[32:35]
    buffer_load_dwordx4 v11, s[16:19], s29 offen offset:1024 nt lds
    v_mfma_f32_16x16x32_bf16 v[32:35], a[120:123], a[24:27], v[32:35]
    v_exp_f32 v23, v23
    v_mfma_f32_16x16x32_bf16 v[32:35], a[124:127], a[28:31], v[32:35]
    ds_read_b64_tr_b16 a[198:199], v3 offset:12288
    v_cvt_pk_bf16_f32 v37, v22, v23
    v_mfma_f32_16x16x32_bf16 v[128:131], a[128:131], v[44:47], v[128:131]
    v_exp_f32 v24, v24
    v_mfma_f32_16x16x32_bf16 v[128:131], a[132:135], v[48:51], v[128:131]
    ds_read_b64_tr_b16 a[200:201], v4 offset:0
    v_mfma_f32_16x16x32_bf16 v[132:135], a[136:139], v[44:47], v[132:135]
    v_exp_f32 v25, v25
    v_mfma_f32_16x16x32_bf16 v[132:135], a[140:143], v[48:51], v[132:135]
    ds_read_b64_tr_b16 a[202:203], v4 offset:4096
    v_cvt_pk_bf16_f32 v38, v24, v25
    v_mfma_f32_16x16x32_bf16 v[136:139], a[144:147], v[44:47], v[136:139]
    v_exp_f32 v26, v26
    v_mfma_f32_16x16x32_bf16 v[136:139], a[148:151], v[48:51], v[136:139]
    buffer_load_dwordx4 v12, s[16:19], s29 offen offset:2048 nt lds
    v_mfma_f32_16x16x32_bf16 v[140:143], a[152:155], v[44:47], v[140:143]
    v_exp_f32 v27, v27
    v_mfma_f32_16x16x32_bf16 v[140:143], a[156:159], v[48:51], v[140:143]
    ds_read_b64_tr_b16 a[204:205], v4 offset:8192
    v_cvt_pk_bf16_f32 v39, v26, v27
    v_mfma_f32_16x16x32_bf16 v[144:147], a[160:163], v[44:47], v[144:147]
    v_exp_f32 v28, v28
    v_mfma_f32_16x16x32_bf16 v[144:147], a[164:167], v[48:51], v[144:147]
    ds_read_b64_tr_b16 a[206:207], v4 offset:12288
    v_mfma_f32_16x16x32_bf16 v[148:151], a[168:171], v[44:47], v[148:151]
    v_exp_f32 v29, v29
    v_mfma_f32_16x16x32_bf16 v[148:151], a[172:175], v[48:51], v[148:151]
    ds_read_b64_tr_b16 a[208:209], v3 offset:256
    v_cvt_pk_bf16_f32 v40, v28, v29
    v_mfma_f32_16x16x32_bf16 v[152:155], a[176:179], v[44:47], v[152:155]
    v_exp_f32 v30, v30
    v_mfma_f32_16x16x32_bf16 v[152:155], a[180:183], v[48:51], v[152:155]
    buffer_load_dwordx4 v13, s[16:19], s29 offen offset:3072 nt lds
    v_mfma_f32_16x16x32_bf16 v[156:159], a[184:187], v[44:47], v[156:159]
    v_exp_f32 v31, v31
    v_mfma_f32_16x16x32_bf16 v[156:159], a[188:191], v[48:51], v[156:159]
PG4:
    s_cbranch_vccnz BODY
    ds_read_b64_tr_b16 a[210:211], v3 offset:4352
    v_cvt_pk_bf16_f32 v41, v30, v31
    v_smfmac_f32_16x16x64_bf16 v[52:55], v[16:19], v[44:51], v14
    ds_read_b64_tr_b16 a[212:213], v3 offset:8448
    v_mfma_f32_16x16x32_bf16 v[20:23], a[64:67], a[32:35], 0
    v_exp_f32 v32, v32
    v_mfma_f32_16x16x32_bf16 v[20:23], a[68:71], a[36:39], v[20:23]
    ds_read_b64_tr_b16 a[214:215], v3 offset:12544
    v_mfma_f32_16x16x32_bf16 v[20:23], a[72:75], a[40:43], v[20:23]
    v_exp_f32 v33, v33
    v_mfma_f32_16x16x32_bf16 v[20:23], a[76:79], a[44:47], v[20:23]
    v_cvt_pk_bf16_f32 v42, v32, v33
    s_add_u32 m0, s30, 49152
    v_mfma_f32_16x16x32_bf16 v[24:27], a[80:83], a[32:35], 0
    v_exp_f32 v34, v34
    v_mfma_f32_16x16x32_bf16 v[24:27], a[84:87], a[36:39], v[24:27]
    buffer_load_dwordx4 v10, s[20:23], s29 offen offset:0 nt lds
    v_mfma_f32_16x16x32_bf16 v[24:27], a[88:91], a[40:43], v[24:27]
    v_exp_f32 v35, v35
    v_mfma_f32_16x16x32_bf16 v[24:27], a[92:95], a[44:47], v[24:27]
    ds_read_b64_tr_b16 a[216:217], v4 offset:256
    v_cvt_pk_bf16_f32 v43, v34, v35
    v_mfma_f32_16x16x32_bf16 v[28:31], a[96:99], a[32:35], 0
    v_exp_f32 v20, v20
    v_mfma_f32_16x16x32_bf16 v[28:31], a[100:103], a[36:39], v[28:31]
    ds_read_b64_tr_b16 a[218:219], v4 offset:4352
    v_mfma_f32_16x16x32_bf16 v[28:31], a[104:107], a[40:43], v[28:31]
    v_exp_f32 v21, v21
    v_mfma_f32_16x16x32_bf16 v[28:31], a[108:111], a[44:47], v[28:31]
    ds_read_b64_tr_b16 a[220:221], v4 offset:8448
    v_cvt_pk_bf16_f32 v44, v20, v21
    v_mfma_f32_16x16x32_bf16 v[32:35], a[112:115], a[32:35], 0
    v_exp_f32 v22, v22
    v_mfma_f32_16x16x32_bf16 v[32:35], a[116:119], a[36:39], v[32:35]
    buffer_load_dwordx4 v11, s[20:23], s29 offen offset:1024 nt lds
    v_mfma_f32_16x16x32_bf16 v[32:35], a[120:123], a[40:43], v[32:35]
    v_exp_f32 v23, v23
    v_mfma_f32_16x16x32_bf16 v[32:35], a[124:127], a[44:47], v[32:35]
    ds_read_b64_tr_b16 a[222:223], v4 offset:12544
    v_cvt_pk_bf16_f32 v45, v22, v23
    v_mfma_f32_16x16x32_bf16 v[160:163], a[128:131], v[36:39], v[160:163]
    v_exp_f32 v24, v24
    v_mfma_f32_16x16x32_bf16 v[160:163], a[132:135], v[40:43], v[160:163]
    ds_read_b64_tr_b16 a[224:225], v3 offset:512
    v_mfma_f32_16x16x32_bf16 v[164:167], a[136:139], v[36:39], v[164:167]
    v_exp_f32 v25, v25
    v_mfma_f32_16x16x32_bf16 v[164:167], a[140:143], v[40:43], v[164:167]
    ds_read_b64_tr_b16 a[226:227], v3 offset:4608
    v_cvt_pk_bf16_f32 v46, v24, v25
    v_mfma_f32_16x16x32_bf16 v[168:171], a[144:147], v[36:39], v[168:171]
    v_exp_f32 v26, v26
    v_mfma_f32_16x16x32_bf16 v[168:171], a[148:151], v[40:43], v[168:171]
    buffer_load_dwordx4 v12, s[20:23], s29 offen offset:2048 nt lds
    v_mfma_f32_16x16x32_bf16 v[172:175], a[152:155], v[36:39], v[172:175]
    v_exp_f32 v27, v27
    v_mfma_f32_16x16x32_bf16 v[172:175], a[156:159], v[40:43], v[172:175]
    ds_read_b64_tr_b16 a[228:229], v3 offset:8704
    v_cvt_pk_bf16_f32 v47, v26, v27
    v_mfma_f32_16x16x32_bf16 v[176:179], a[160:163], v[36:39], v[176:179]
    v_exp_f32 v28, v28
    v_mfma_f32_16x16x32_bf16 v[176:179], a[164:167], v[40:43], v[176:179]
    ds_read_b64_tr_b16 a[230:231], v3 offset:12800
    v_mfma_f32_16x16x32_bf16 v[180:183], a[168:171], v[36:39], v[180:183]
    v_exp_f32 v29, v29
    v_mfma_f32_16x16x32_bf16 v[180:183], a[172:175], v[40:43], v[180:183]
    ds_read_b64_tr_b16 a[232:233], v4 offset:512
    v_cvt_pk_bf16_f32 v48, v28, v29
    v_mfma_f32_16x16x32_bf16 v[184:187], a[176:179], v[36:39], v[184:187]
    v_exp_f32 v30, v30
    v_mfma_f32_16x16x32_bf16 v[184:187], a[180:183], v[40:43], v[184:187]
    buffer_load_dwordx4 v13, s[20:23], s29 offen offset:3072 nt lds
    v_mfma_f32_16x16x32_bf16 v[188:191], a[184:187], v[36:39], v[188:191]
    v_exp_f32 v31, v31
    v_mfma_f32_16x16x32_bf16 v[188:191], a[188:191], v[40:43], v[188:191]
    ds_read_b64_tr_b16 a[234:235], v4 offset:4608
    v_cvt_pk_bf16_f32 v49, v30, v31
    v_smfmac_f32_16x16x64_bf16 v[56:59], v[16:19], v[36:43], v14
    ds_read_b64_tr_b16 a[236:237], v4 offset:8704
    s_add_u32 s29, s29, 16384
    v_mfma_f32_16x16x32_bf16 v[20:23], a[64:67], a[48:51], 0
    v_exp_f32 v32, v32
    v_mfma_f32_16x16x32_bf16 v[20:23], a[68:71], a[52:55], v[20:23]
    ds_read_b128 a[64:67], v2 offset:0
    ds_read_b128 a[68:71], v2 offset:256
    v_mfma_f32_16x16x32_bf16 v[20:23], a[72:75], a[56:59], v[20:23]
    v_exp_f32 v33, v33
    v_mfma_f32_16x16x32_bf16 v[20:23], a[76:79], a[60:63], v[20:23]
    ds_read_b128 a[72:75], v2 offset:512
    v_cvt_pk_bf16_f32 v50, v32, v33
    v_mfma_f32_16x16x32_bf16 v[24:27], a[80:83], a[48:51], 0
    v_exp_f32 v34, v34
    v_mfma_f32_16x16x32_bf16 v[24:27], a[84:87], a[52:55], v[24:27]
    ds_read_b128 a[76:79], v2 offset:768
    s_add_u32 s30, s30, s32
    v_mfma_f32_16x16x32_bf16 v[24:27], a[88:91], a[56:59], v[24:27]
    v_exp_f32 v35, v35
    v_mfma_f32_16x16x32_bf16 v[24:27], a[92:95], a[60:63], v[24:27]
    ds_read_b128 a[80:83], v2 offset:4096
    v_cvt_pk_bf16_f32 v51, v34, v35
    v_mfma_f32_16x16x32_bf16 v[28:31], a[96:99], a[48:51], 0
    v_exp_f32 v20, v20
    v_mfma_f32_16x16x32_bf16 v[28:31], a[100:103], a[52:55], v[28:31]
    ds_read_b128 a[84:87], v2 offset:4352
    v_mfma_f32_16x16x32_bf16 v[28:31], a[104:107], a[56:59], v[28:31]
    v_exp_f32 v21, v21
    v_mfma_f32_16x16x32_bf16 v[28:31], a[108:111], a[60:63], v[28:31]
    ds_read_b128 a[88:91], v2 offset:4608
    v_cvt_pk_bf16_f32 v36, v20, v21
    v_mfma_f32_16x16x32_bf16 v[32:35], a[112:115], a[48:51], 0
    v_exp_f32 v22, v22
    v_mfma_f32_16x16x32_bf16 v[32:35], a[116:119], a[52:55], v[32:35]
    ds_read_b128 a[92:95], v2 offset:4864
    v_mfma_f32_16x16x32_bf16 v[32:35], a[120:123], a[56:59], v[32:35]
    v_exp_f32 v23, v23
    v_mfma_f32_16x16x32_bf16 v[32:35], a[124:127], a[60:63], v[32:35]
    ds_read_b128 a[96:99], v2 offset:8192
    v_cvt_pk_bf16_f32 v37, v22, v23
    v_mfma_f32_16x16x32_bf16 v[192:195], a[128:131], v[44:47], v[192:195]
    v_exp_f32 v24, v24
    v_mfma_f32_16x16x32_bf16 v[192:195], a[132:135], v[48:51], v[192:195]
    ds_read_b128 a[100:103], v2 offset:8448
    v_mfma_f32_16x16x32_bf16 v[196:199], a[136:139], v[44:47], v[196:199]
    v_exp_f32 v25, v25
    v_mfma_f32_16x16x32_bf16 v[196:199], a[140:143], v[48:51], v[196:199]
    ds_read_b128 a[104:107], v2 offset:8704
    v_cvt_pk_bf16_f32 v38, v24, v25
    v_mfma_f32_16x16x32_bf16 v[200:203], a[144:147], v[44:47], v[200:203]
    v_exp_f32 v26, v26
    v_mfma_f32_16x16x32_bf16 v[200:203], a[148:151], v[48:51], v[200:203]
    ds_read_b128 a[108:111], v2 offset:8960
    v_mfma_f32_16x16x32_bf16 v[204:207], a[152:155], v[44:47], v[204:207]
    v_exp_f32 v27, v27
    v_mfma_f32_16x16x32_bf16 v[204:207], a[156:159], v[48:51], v[204:207]
    ds_read_b128 a[112:115], v2 offset:12288
    v_cvt_pk_bf16_f32 v39, v26, v27
    v_mfma_f32_16x16x32_bf16 v[208:211], a[160:163], v[44:47], v[208:211]
    v_exp_f32 v28, v28
    v_mfma_f32_16x16x32_bf16 v[208:211], a[164:167], v[48:51], v[208:211]
    ds_read_b128 a[116:119], v2 offset:12544
    v_mfma_f32_16x16x32_bf16 v[212:215], a[168:171], v[44:47], v[212:215]
    v_exp_f32 v29, v29
    v_mfma_f32_16x16x32_bf16 v[212:215], a[172:175], v[48:51], v[212:215]
    ds_read_b128 a[120:123], v2 offset:12800
    v_cvt_pk_bf16_f32 v40, v28, v29
    v_mfma_f32_16x16x32_bf16 v[216:219], a[176:179], v[44:47], v[216:219]
    v_exp_f32 v30, v30
    v_mfma_f32_16x16x32_bf16 v[216:219], a[180:183], v[48:51], v[216:219]
    ds_read_b128 a[124:127], v2 offset:13056
    v_mfma_f32_16x16x32_bf16 v[220:223], a[184:187], v[44:47], v[220:223]
    v_exp_f32 v31, v31
    v_mfma_f32_16x16x32_bf16 v[220:223], a[188:191], v[48:51], v[220:223]
    v_cvt_pk_bf16_f32 v41, v30, v31
    ds_read_b128 v[72:75], v81 offset:512
    v_smfmac_f32_16x16x64_bf16 v[60:63], v[16:19], v[44:51], v14
    s_waitcnt lgkmcnt(5)
    v_add_u32 v81, 1024, v81
    v_mfma_f32_16x16x32_bf16 v[20:23], a[64:67], a[0:3], 0
    v_exp_f32 v32, v32
    v_mfma_f32_16x16x32_bf16 v[20:23], a[68:71], a[4:7], v[20:23]
    ds_read_b64_tr_b16 a[238:239], v4 offset:12800
    v_mfma_f32_16x16x32_bf16 v[20:23], a[72:75], a[8:11], v[20:23]
    v_exp_f32 v33, v33
    v_mfma_f32_16x16x32_bf16 v[20:23], a[76:79], a[12:15], v[20:23]
    ds_read_b64_tr_b16 a[240:241], v3 offset:768
    v_cvt_pk_bf16_f32 v42, v32, v33
    v_mfma_f32_16x16x32_bf16 v[24:27], a[80:83], a[0:3], 0
    v_exp_f32 v34, v34
    v_mfma_f32_16x16x32_bf16 v[24:27], a[84:87], a[4:7], v[24:27]
    ds_read_b64_tr_b16 a[242:243], v3 offset:4864
    v_mfma_f32_16x16x32_bf16 v[24:27], a[88:91], a[8:11], v[24:27]
    v_exp_f32 v35, v35
    v_mfma_f32_16x16x32_bf16 v[24:27], a[92:95], a[12:15], v[24:27]
    ds_read_b64_tr_b16 a[244:245], v3 offset:8960
    v_cvt_pk_bf16_f32 v43, v34, v35
    v_mfma_f32_16x16x32_bf16 v[28:31], a[96:99], a[0:3], 0
    v_exp_f32 v20, v20
    v_mfma_f32_16x16x32_bf16 v[28:31], a[100:103], a[4:7], v[28:31]
    ds_read_b64_tr_b16 a[246:247], v3 offset:13056
    v_mfma_f32_16x16x32_bf16 v[28:31], a[104:107], a[8:11], v[28:31]
    v_exp_f32 v21, v21
    v_mfma_f32_16x16x32_bf16 v[28:31], a[108:111], a[12:15], v[28:31]
    v_cvt_pk_bf16_f32 v44, v20, v21
    s_waitcnt lgkmcnt(6)
    v_mfma_f32_16x16x32_bf16 v[32:35], a[112:115], a[0:3], 0
    v_exp_f32 v22, v22
    v_mfma_f32_16x16x32_bf16 v[32:35], a[116:119], a[4:7], v[32:35]
    ds_read_b64_tr_b16 a[248:249], v4 offset:768
    v_mfma_f32_16x16x32_bf16 v[32:35], a[120:123], a[8:11], v[32:35]
    v_exp_f32 v23, v23
    v_mfma_f32_16x16x32_bf16 v[32:35], a[124:127], a[12:15], v[32:35]
    ds_read_b64_tr_b16 a[250:251], v4 offset:4864
    v_cvt_pk_bf16_f32 v45, v22, v23
    v_mfma_f32_16x16x32_bf16 v[224:227], a[128:131], v[36:39], v[224:227]
    v_exp_f32 v24, v24
    v_mfma_f32_16x16x32_bf16 v[224:227], a[132:135], v[40:43], v[224:227]
    ds_read_b64_tr_b16 a[252:253], v4 offset:8960
    v_mfma_f32_16x16x32_bf16 v[228:231], a[136:139], v[36:39], v[228:231]
    v_exp_f32 v25, v25
    v_mfma_f32_16x16x32_bf16 v[228:231], a[140:143], v[40:43], v[228:231]
    ds_read_b64_tr_b16 a[254:255], v4 offset:13056
    v_cvt_pk_bf16_f32 v46, v24, v25
    v_mfma_f32_16x16x32_bf16 v[232:235], a[144:147], v[36:39], v[232:235]
    v_exp_f32 v26, v26
    v_mfma_f32_16x16x32_bf16 v[232:235], a[148:151], v[40:43], v[232:235]
    s_waitcnt lgkmcnt(9)
    buffer_store_dwordx4 v[72:75], v6, s[24:27], s37 offen offset:1024 nt
    v_mfma_f32_16x16x32_bf16 v[236:239], a[152:155], v[36:39], v[236:239]
    v_exp_f32 v27, v27
    v_mfma_f32_16x16x32_bf16 v[236:239], a[156:159], v[40:43], v[236:239]
    v_cvt_pk_bf16_f32 v47, v26, v27
    s_add_u32 s37, s37, 2048
    v_mfma_f32_16x16x32_bf16 v[240:243], a[160:163], v[36:39], v[240:243]
    v_exp_f32 v28, v28
    v_mfma_f32_16x16x32_bf16 v[240:243], a[164:167], v[40:43], v[240:243]
    s_cmp_eq_u32 s30, s31
    s_cselect_b32 s32, 0xffff8000, s38
    v_mfma_f32_16x16x32_bf16 v[244:247], a[168:171], v[36:39], v[244:247]
    v_exp_f32 v29, v29
    v_mfma_f32_16x16x32_bf16 v[244:247], a[172:175], v[40:43], v[244:247]
    v_cvt_pk_bf16_f32 v48, v28, v29
    v_add_u32 v3, s32, v3
    v_mfma_f32_16x16x32_bf16 v[248:251], a[176:179], v[36:39], v[248:251]
    v_exp_f32 v30, v30
    v_mfma_f32_16x16x32_bf16 v[248:251], a[180:183], v[40:43], v[248:251]
    v_add_u32 v4, s32, v4
    v_add_u32 v2, s32, v2
    v_mfma_f32_16x16x32_bf16 v[252:255], a[184:187], v[36:39], v[252:255]
    v_exp_f32 v31, v31
    v_mfma_f32_16x16x32_bf16 v[252:255], a[188:191], v[40:43], v[252:255]
    v_cvt_pk_bf16_f32 v49, v30, v31
    v_smfmac_f32_16x16x64_bf16 v[64:67], v[16:19], v[36:43], v14
    s_branch LOOPS
T31:
    v_mfma_f32_16x16x32_bf16 v[20:23], a[64:67], a[16:19], 0
    v_exp_f32 v32, v32
    v_mfma_f32_16x16x32_bf16 v[20:23], a[68:71], a[20:23], v[20:23]
    s_waitcnt vmcnt(10) lgkmcnt(0)
    s_barrier
    v_mfma_f32_16x16x32_bf16 v[20:23], a[72:75], a[24:27], v[20:23]
    v_exp_f32 v33, v33
    v_mfma_f32_16x16x32_bf16 v[20:23], a[76:79], a[28:31], v[20:23]
    ds_read_b64_tr_b16 a[192:193], v3 offset:0
    v_cvt_pk_bf16_f32 v50, v32, v33
    v_mfma_f32_16x16x32_bf16 v[24:27], a[80:83], a[16:19], 0
    v_exp_f32 v34, v34
    v_mfma_f32_16x16x32_bf16 v[24:27], a[84:87], a[20:23], v[24:27]
    ds_read_b64_tr_b16 a[194:195], v3 offset:4096
    ds_read_b64_tr_b16 a[196:197], v3 offset:8192
    v_mfma_f32_16x16x32_bf16 v[24:27], a[88:91], a[24:27], v[24:27]
    v_exp_f32 v35, v35
    v_mfma_f32_16x16x32_bf16 v[24:27], a[92:95], a[28:31], v[24:27]
    ds_read_b64_tr_b16 a[198:199], v3 offset:12288
    v_cvt_pk_bf16_f32 v51, v34, v35
    v_mfma_f32_16x16x32_bf16 v[28:31], a[96:99], a[16:19], 0
    v_exp_f32 v20, v20
    v_mfma_f32_16x16x32_bf16 v[28:31], a[100:103], a[20:23], v[28:31]
    ds_read_b64_tr_b16 a[224:225], v3 offset:512
    v_exp_f32 v21, v21
    v_mfma_f32_16x16x32_bf16 v[28:31], a[104:107], a[24:27], v[28:31]
    v_exp_f32 v22, v22
    v_cvt_pk_bf16_f32 v36, v20, v21
    v_mfma_f32_16x16x32_bf16 v[28:31], a[108:111], a[28:31], v[28:31]
    ds_read_b64_tr_b16 a[226:227], v3 offset:4608
    v_exp_f32 v23, v23
    v_mfma_f32_16x16x32_bf16 v[32:35], a[112:115], a[16:19], 0
    v_exp_f32 v24, v24
    v_cvt_pk_bf16_f32 v37, v22, v23
    v_mfma_f32_16x16x32_bf16 v[32:35], a[116:119], a[20:23], v[32:35]
    ds_read_b64_tr_b16 a[228:229], v3 offset:8704
    v_exp_f32 v25, v25
    v_mfma_f32_16x16x32_bf16 v[32:35], a[120:123], a[24:27], v[32:35]
    v_exp_f32 v26, v26
    v_cvt_pk_bf16_f32 v38, v24, v25
    v_mfma_f32_16x16x32_bf16 v[32:35], a[124:127], a[28:31], v[32:35]
    ds_read_b64_tr_b16 a[230:231], v3 offset:12800
    v_exp_f32 v27, v27
    v_mfma_f32_16x16x32_bf16 v[20:23], a[64:67], a[32:35], 0
    v_exp_f32 v28, v28
    v_cvt_pk_bf16_f32 v39, v26, v27
    v_mfma_f32_16x16x32_bf16 v[20:23], a[68:71], a[36:39], v[20:23]
    ds_read_b64_tr_b16 a[200:201], v4 offset:0
    v_exp_f32 v29, v29
    v_mfma_f32_16x16x32_bf16 v[20:23], a[72:75], a[40:43], v[20:23]
    v_exp_f32 v30, v30
    v_cvt_pk_bf16_f32 v40, v28, v29
    v_mfma_f32_16x16x32_bf16 v[20:23], a[76:79], a[44:47], v[20:23]
    ds_read_b64_tr_b16 a[202:203], v4 offset:4096
    v_exp_f32 v31, v31
    v_mfma_f32_16x16x32_bf16 v[24:27], a[80:83], a[32:35], 0
    v_exp_f32 v32, v32
    v_cvt_pk_bf16_f32 v41, v30, v31
    v_mfma_f32_16x16x32_bf16 v[24:27], a[84:87], a[36:39], v[24:27]
    ds_read_b64_tr_b16 a[204:205], v4 offset:8192
    v_exp_f32 v33, v33
    v_mfma_f32_16x16x32_bf16 v[24:27], a[88:91], a[40:43], v[24:27]
    v_exp_f32 v34, v34
    v_cvt_pk_bf16_f32 v42, v32, v33
    v_mfma_f32_16x16x32_bf16 v[24:27], a[92:95], a[44:47], v[24:27]
    ds_read_b64_tr_b16 a[206:207], v4 offset:12288
    v_exp_f32 v35, v35
    v_mfma_f32_16x16x32_bf16 v[28:31], a[96:99], a[32:35], 0
    v_exp_f32 v20, v20
    v_cvt_pk_bf16_f32 v43, v34, v35
    v_mfma_f32_16x16x32_bf16 v[28:31], a[100:103], a[36:39], v[28:31]
    ds_read_b64_tr_b16 a[232:233], v4 offset:512
    v_exp_f32 v21, v21
    v_mfma_f32_16x16x32_bf16 v[28:31], a[104:107], a[40:43], v[28:31]
    v_exp_f32 v22, v22
    v_cvt_pk_bf16_f32 v68, v20, v21
    v_mfma_f32_16x16x32_bf16 v[28:31], a[108:111], a[44:47], v[28:31]
    ds_read_b64_tr_b16 a[234:235], v4 offset:4608
    v_exp_f32 v23, v23
    v_mfma_f32_16x16x32_bf16 v[32:35], a[112:115], a[32:35], 0
    v_exp_f32 v24, v24
    v_cvt_pk_bf16_f32 v69, v22, v23
    v_mfma_f32_16x16x32_bf16 v[32:35], a[116:119], a[36:39], v[32:35]
    ds_read_b64_tr_b16 a[236:237], v4 offset:8704
    v_exp_f32 v25, v25
    v_mfma_f32_16x16x32_bf16 v[32:35], a[120:123], a[40:43], v[32:35]
    v_exp_f32 v26, v26
    v_cvt_pk_bf16_f32 v70, v24, v25
    v_mfma_f32_16x16x32_bf16 v[32:35], a[124:127], a[44:47], v[32:35]
    ds_read_b64_tr_b16 a[238:239], v4 offset:12800
    v_exp_f32 v27, v27
    v_mfma_f32_16x16x32_bf16 v[20:23], a[64:67], a[48:51], 0
    v_exp_f32 v28, v28
    v_cvt_pk_bf16_f32 v71, v26, v27
    v_mfma_f32_16x16x32_bf16 v[20:23], a[68:71], a[52:55], v[20:23]
    ds_read_b64_tr_b16 a[208:209], v3 offset:256
    v_exp_f32 v29, v29
    v_mfma_f32_16x16x32_bf16 v[20:23], a[72:75], a[56:59], v[20:23]
    v_exp_f32 v30, v30
    v_cvt_pk_bf16_f32 v72, v28, v29
    v_mfma_f32_16x16x32_bf16 v[20:23], a[76:79], a[60:63], v[20:23]
    ds_read_b64_tr_b16 a[210:211], v3 offset:4352
    v_exp_f32 v31, v31
    v_mfma_f32_16x16x32_bf16 v[24:27], a[80:83], a[48:51], 0
    v_exp_f32 v32, v32
    v_cvt_pk_bf16_f32 v73, v30, v31
    v_mfma_f32_16x16x32_bf16 v[24:27], a[84:87], a[52:55], v[24:27]
    ds_read_b64_tr_b16 a[212:213], v3 offset:8448
    v_exp_f32 v33, v33
    v_mfma_f32_16x16x32_bf16 v[24:27], a[88:91], a[56:59], v[24:27]
    v_exp_f32 v34, v34
    v_cvt_pk_bf16_f32 v74, v32, v33
    v_mfma_f32_16x16x32_bf16 v[24:27], a[92:95], a[60:63], v[24:27]
    ds_read_b64_tr_b16 a[214:215], v3 offset:12544
    v_exp_f32 v35, v35
    v_mfma_f32_16x16x32_bf16 v[28:31], a[96:99], a[48:51], 0
    v_exp_f32 v20, v20
    v_cvt_pk_bf16_f32 v75, v34, v35
    v_mfma_f32_16x16x32_bf16 v[28:31], a[100:103], a[52:55], v[28:31]
    ds_read_b128 a[64:67], v2 offset:0
    ds_read_b128 a[68:71], v2 offset:256
    v_mfma_f32_16x16x32_bf16 v[28:31], a[104:107], a[56:59], v[28:31]
    v_exp_f32 v21, v21
    v_mfma_f32_16x16x32_bf16 v[28:31], a[108:111], a[60:63], v[28:31]
    ds_read_b128 a[72:75], v2 offset:512
    v_cvt_pk_bf16_f32 v100, v20, v21
    v_mfma_f32_16x16x32_bf16 v[32:35], a[112:115], a[48:51], 0
    v_exp_f32 v22, v22
    v_mfma_f32_16x16x32_bf16 v[32:35], a[116:119], a[52:55], v[32:35]
    ds_read_b128 a[76:79], v2 offset:768
    ds_read_b128 a[80:83], v2 offset:4096
    v_mfma_f32_16x16x32_bf16 v[32:35], a[120:123], a[56:59], v[32:35]
    v_exp_f32 v23, v23
    v_mfma_f32_16x16x32_bf16 v[32:35], a[124:127], a[60:63], v[32:35]
    ds_read_b128 a[84:87], v2 offset:4352
    v_cvt_pk_bf16_f32 v101, v22, v23
    v_mfma_f32_16x16x32_bf16 v[128:131], a[128:131], v[44:47], v[128:131]
    v_exp_f32 v24, v24
    v_mfma_f32_16x16x32_bf16 v[128:131], a[132:135], v[48:51], v[128:131]
    ds_read_b128 a[88:91], v2 offset:4608
    ds_read_b128 a[92:95], v2 offset:4864
    v_mfma_f32_16x16x32_bf16 v[144:147], a[160:163], v[44:47], v[144:147]
    v_exp_f32 v25, v25
    v_mfma_f32_16x16x32_bf16 v[144:147], a[164:167], v[48:51], v[144:147]
    ds_read_b128 a[96:99], v2 offset:8192
    v_cvt_pk_bf16_f32 v102, v24, v25
    v_mfma_f32_16x16x32_bf16 v[132:135], a[136:139], v[44:47], v[132:135]
    v_exp_f32 v26, v26
    v_mfma_f32_16x16x32_bf16 v[132:135], a[140:143], v[48:51], v[132:135]
    ds_read_b128 a[100:103], v2 offset:8448
    ds_read_b128 a[104:107], v2 offset:8704
    v_mfma_f32_16x16x32_bf16 v[148:151], a[168:171], v[44:47], v[148:151]
    v_exp_f32 v27, v27
    v_mfma_f32_16x16x32_bf16 v[148:151], a[172:175], v[48:51], v[148:151]
    ds_read_b128 a[108:111], v2 offset:8960
    v_cvt_pk_bf16_f32 v103, v26, v27
    v_mfma_f32_16x16x32_bf16 v[136:139], a[144:147], v[44:47], v[136:139]
    v_exp_f32 v28, v28
    v_mfma_f32_16x16x32_bf16 v[136:139], a[148:151], v[48:51], v[136:139]
    ds_read_b128 a[112:115], v2 offset:12288
    ds_read_b128 a[116:119], v2 offset:12544
    v_mfma_f32_16x16x32_bf16 v[152:155], a[176:179], v[44:47], v[152:155]
    v_exp_f32 v29, v29
    v_mfma_f32_16x16x32_bf16 v[152:155], a[180:183], v[48:51], v[152:155]
    ds_read_b128 a[120:123], v2 offset:12800
    v_cvt_pk_bf16_f32 v104, v28, v29
    v_mfma_f32_16x16x32_bf16 v[140:143], a[152:155], v[44:47], v[140:143]
    v_exp_f32 v30, v30
    v_mfma_f32_16x16x32_bf16 v[140:143], a[156:159], v[48:51], v[140:143]
    ds_read_b128 a[124:127], v2 offset:13056
    ds_read_b128 v[84:87], v81 offset:512
    v_mfma_f32_16x16x32_bf16 v[156:159], a[184:187], v[44:47], v[156:159]
    v_exp_f32 v31, v31
    v_mfma_f32_16x16x32_bf16 v[156:159], a[188:191], v[48:51], v[156:159]
    v_cvt_pk_bf16_f32 v105, v30, v31
    v_smfmac_f32_16x16x64_bf16 v[52:55], v[16:19], v[44:51], v14
    v_exp_f32 v32, v32
    s_waitcnt lgkmcnt(9)
    v_mfma_f32_16x16x32_bf16 v[20:23], a[64:67], a[0:3], 0
    ds_read_b64_tr_b16 a[240:241], v3 offset:768
    ds_read_b64_tr_b16 a[242:243], v3 offset:4864
    v_mfma_f32_16x16x32_bf16 v[20:23], a[68:71], a[4:7], v[20:23]
    v_exp_f32 v33, v33
    v_mfma_f32_16x16x32_bf16 v[20:23], a[72:75], a[8:11], v[20:23]
    ds_read_b64_tr_b16 a[244:245], v3 offset:8960
    v_cvt_pk_bf16_f32 v106, v32, v33
    v_mfma_f32_16x16x32_bf16 v[20:23], a[76:79], a[12:15], v[20:23]
    v_exp_f32 v34, v34
    v_mfma_f32_16x16x32_bf16 v[24:27], a[80:83], a[0:3], 0
    ds_read_b64_tr_b16 a[246:247], v3 offset:13056
    ds_read_b64_tr_b16 a[216:217], v4 offset:256
    v_mfma_f32_16x16x32_bf16 v[24:27], a[84:87], a[4:7], v[24:27]
    v_exp_f32 v35, v35
    v_mfma_f32_16x16x32_bf16 v[24:27], a[88:91], a[8:11], v[24:27]
    ds_read_b64_tr_b16 a[218:219], v4 offset:4352
    v_cvt_pk_bf16_f32 v107, v34, v35
    v_mfma_f32_16x16x32_bf16 v[24:27], a[92:95], a[12:15], v[24:27]
    s_waitcnt lgkmcnt(7)
    ds_read_b64_tr_b16 a[220:221], v4 offset:8448
    ds_read_b64_tr_b16 a[222:223], v4 offset:12544
    v_mfma_f32_16x16x32_bf16 v[28:31], a[96:99], a[0:3], 0
    v_exp_f32 v20, v20
    v_mfma_f32_16x16x32_bf16 v[28:31], a[100:103], a[4:7], v[28:31]
    ds_read_b64_tr_b16 a[248:249], v4 offset:768
    v_exp_f32 v21, v21
    v_mfma_f32_16x16x32_bf16 v[28:31], a[104:107], a[8:11], v[28:31]
    v_exp_f32 v22, v22
    v_cvt_pk_bf16_f32 v108, v20, v21
    v_mfma_f32_16x16x32_bf16 v[28:31], a[108:111], a[12:15], v[28:31]
    ds_read_b64_tr_b16 a[250:251], v4 offset:4864
    v_exp_f32 v23, v23
    v_mfma_f32_16x16x32_bf16 v[32:35], a[112:115], a[0:3], 0
    v_exp_f32 v24, v24
    v_cvt_pk_bf16_f32 v109, v22, v23
    v_mfma_f32_16x16x32_bf16 v[32:35], a[116:119], a[4:7], v[32:35]
    ds_read_b64_tr_b16 a[252:253], v4 offset:8960
    v_exp_f32 v25, v25
    v_mfma_f32_16x16x32_bf16 v[32:35], a[120:123], a[8:11], v[32:35]
    v_exp_f32 v26, v26
    v_cvt_pk_bf16_f32 v110, v24, v25
    v_mfma_f32_16x16x32_bf16 v[32:35], a[124:127], a[12:15], v[32:35]
    ds_read_b64_tr_b16 a[254:255], v4 offset:13056
    v_exp_f32 v27, v27
    v_mfma_f32_16x16x32_bf16 v[20:23], a[64:67], a[16:19], 0
    v_exp_f32 v28, v28
    v_cvt_pk_bf16_f32 v111, v26, v27
    v_mfma_f32_16x16x32_bf16 v[20:23], a[68:71], a[20:23], v[20:23]
    v_exp_f32 v29, v29
    v_mfma_f32_16x16x32_bf16 v[20:23], a[72:75], a[24:27], v[20:23]
    v_exp_f32 v30, v30
    v_cvt_pk_bf16_f32 v112, v28, v29
    v_mfma_f32_16x16x32_bf16 v[20:23], a[76:79], a[28:31], v[20:23]
    v_exp_f32 v31, v31
    v_mfma_f32_16x16x32_bf16 v[24:27], a[80:83], a[16:19], 0
    v_exp_f32 v32, v32
    v_cvt_pk_bf16_f32 v113, v30, v31
    v_mfma_f32_16x16x32_bf16 v[24:27], a[84:87], a[20:23], v[24:27]
    v_exp_f32 v33, v33
    v_mfma_f32_16x16x32_bf16 v[24:27], a[88:91], a[24:27], v[24:27]
    v_exp_f32 v34, v34
    v_cvt_pk_bf16_f32 v114, v32, v33
    v_mfma_f32_16x16x32_bf16 v[24:27], a[92:95], a[28:31], v[24:27]
    v_exp_f32 v35, v35
    v_mfma_f32_16x16x32_bf16 v[28:31], a[96:99], a[16:19], 0
    v_exp_f32 v20, v20
    v_cvt_pk_bf16_f32 v115, v34, v35
    v_mfma_f32_16x16x32_bf16 v[28:31], a[100:103], a[20:23], v[28:31]
    v_exp_f32 v21, v21
    s_waitcnt lgkmcnt(12)
    buffer_store_dwordx4 v[84:87], v6, s[24:27], s37 offen offset:1024 nt
    v_mfma_f32_16x16x32_bf16 v[28:31], a[104:107], a[24:27], v[28:31]
    v_cvt_pk_bf16_f32 v44, v20, v21
    v_mfma_f32_16x16x32_bf16 v[28:31], a[108:111], a[28:31], v[28:31]
    v_exp_f32 v22, v22
    s_mov_b32 s37, 131072
    v_smfmac_f32_16x16x64_bf16 v[52:55], v[16:19], v[108:115], v14
    v_exp_f32 v23, v23
    v_mfma_f32_16x16x32_bf16 v[32:35], a[112:115], a[16:19], 0
    v_cvt_pk_bf16_f32 v45, v22, v23
    v_mfma_f32_16x16x32_bf16 v[32:35], a[116:119], a[20:23], v[32:35]
    v_exp_f32 v24, v24
    v_mfma_f32_16x16x32_bf16 v[32:35], a[120:123], a[24:27], v[32:35]
    v_exp_f32 v25, v25
    v_mfma_f32_16x16x32_bf16 v[32:35], a[124:127], a[28:31], v[32:35]
    v_cvt_pk_bf16_f32 v46, v24, v25
    s_waitcnt lgkmcnt(0)
    v_mfma_f32_16x16x32_bf16 v[128:131], a[192:195], v[108:111], v[128:131]
    v_exp_f32 v26, v26
    v_mfma_f32_16x16x32_bf16 v[128:131], a[196:199], v[112:115], v[128:131]
    v_exp_f32 v27, v27
    v_mfma_f32_16x16x32_bf16 v[144:147], a[224:227], v[108:111], v[144:147]
    v_cvt_pk_bf16_f32 v47, v26, v27
    v_add_f32 v116, v52, v53
    v_rcp_f32 v118, v116
    v_subrev_u32 v116, s35, v116
    v_max_u32 v9, v9, v116
    v_mfma_f32_16x16x32_bf16 v[144:147], a[228:231], v[112:115], v[144:147]
    v_exp_f32 v28, v28
    v_mfma_f32_16x16x32_bf16 v[132:135], a[200:203], v[108:111], v[132:135]
    v_exp_f32 v29, v29
    v_mfma_f32_16x16x32_bf16 v[132:135], a[204:207], v[112:115], v[132:135]
    v_cvt_pk_bf16_f32 v48, v28, v29
    v_mul_f32 v128, v118, v128
    v_mul_f32 v129, v118, v129
    v_mul_f32 v130, v118, v130
    v_mfma_f32_16x16x32_bf16 v[148:151], a[232:235], v[108:111], v[148:151]
    v_exp_f32 v30, v30
    v_mfma_f32_16x16x32_bf16 v[148:151], a[236:239], v[112:115], v[148:151]
    v_exp_f32 v31, v31
    v_mfma_f32_16x16x32_bf16 v[136:139], a[208:211], v[108:111], v[136:139]
    v_cvt_pk_bf16_f32 v49, v30, v31
    v_mul_f32 v131, v118, v131
    v_cvt_pk_bf16_f32 v84, v128, v129
    v_cvt_pk_bf16_f32 v85, v130, v131
    v_mfma_f32_16x16x32_bf16 v[136:139], a[212:215], v[112:115], v[136:139]
    v_exp_f32 v32, v32
    v_mfma_f32_16x16x32_bf16 v[152:155], a[240:243], v[108:111], v[152:155]
    v_exp_f32 v33, v33
    v_mfma_f32_16x16x32_bf16 v[152:155], a[244:247], v[112:115], v[152:155]
    v_cvt_pk_bf16_f32 v50, v32, v33
    v_mul_f32 v144, v118, v144
    v_mul_f32 v145, v118, v145
    v_mul_f32 v146, v118, v146
    v_mul_f32 v147, v118, v147
    v_cvt_pk_bf16_f32 v92, v144, v145
    v_cvt_pk_bf16_f32 v93, v146, v147
    ds_write2st64_b64 v76, v[84:85], v[92:93] offset0:0 offset1:16
    v_mfma_f32_16x16x32_bf16 v[140:143], a[216:219], v[108:111], v[140:143]
    v_exp_f32 v34, v34
    v_mfma_f32_16x16x32_bf16 v[140:143], a[220:223], v[112:115], v[140:143]
    v_exp_f32 v35, v35
    v_mfma_f32_16x16x32_bf16 v[156:159], a[248:251], v[108:111], v[156:159]
    v_cvt_pk_bf16_f32 v51, v34, v35
    v_mul_f32 v132, v118, v132
    v_mfma_f32_16x16x32_bf16 v[156:159], a[252:255], v[112:115], v[156:159]
    v_mul_f32 v133, v118, v133
    v_mul_f32 v134, v118, v134
    v_mul_f32 v135, v118, v135
    v_smfmac_f32_16x16x64_bf16 v[56:59], v[16:19], v[36:43], v14
    v_cvt_pk_bf16_f32 v86, v132, v133
    v_cvt_pk_bf16_f32 v87, v134, v135
    v_mfma_f32_16x16x32_bf16 v[20:23], a[64:67], a[32:35], 0
    v_mul_f32 v148, v118, v148
    v_mul_f32 v149, v118, v149
    v_mfma_f32_16x16x32_bf16 v[20:23], a[68:71], a[36:39], v[20:23]
    v_mul_f32 v150, v118, v150
    v_mul_f32 v151, v118, v151
    v_mfma_f32_16x16x32_bf16 v[20:23], a[72:75], a[40:43], v[20:23]
    v_cvt_pk_bf16_f32 v94, v148, v149
    v_cvt_pk_bf16_f32 v95, v150, v151
    v_mfma_f32_16x16x32_bf16 v[20:23], a[76:79], a[44:47], v[20:23]
    ds_write2st64_b64 v77, v[86:87], v[94:95] offset0:0 offset1:16
    v_mfma_f32_16x16x32_bf16 v[24:27], a[80:83], a[32:35], 0
    v_mul_f32 v136, v118, v136
    v_mul_f32 v137, v118, v137
    v_mfma_f32_16x16x32_bf16 v[24:27], a[84:87], a[36:39], v[24:27]
    v_mul_f32 v138, v118, v138
    v_mfma_f32_16x16x32_bf16 v[24:27], a[88:91], a[40:43], v[24:27]
    v_mul_f32 v139, v118, v139
    v_cvt_pk_bf16_f32 v88, v136, v137
    v_mfma_f32_16x16x32_bf16 v[24:27], a[92:95], a[44:47], v[24:27]
    v_cvt_pk_bf16_f32 v89, v138, v139
    v_mfma_f32_16x16x32_bf16 v[28:31], a[96:99], a[32:35], 0
    v_exp_f32 v20, v20
    v_mfma_f32_16x16x32_bf16 v[28:31], a[100:103], a[36:39], v[28:31]
    v_mul_f32 v152, v118, v152
    v_mul_f32 v153, v118, v153
    v_mul_f32 v154, v118, v154
    v_mfma_f32_16x16x32_bf16 v[28:31], a[104:107], a[40:43], v[28:31]
    v_mul_f32 v155, v118, v155
    v_cvt_pk_bf16_f32 v96, v152, v153
    v_cvt_pk_bf16_f32 v97, v154, v155
    ds_write2st64_b64 v78, v[88:89], v[96:97] offset0:0 offset1:16
    v_mfma_f32_16x16x32_bf16 v[28:31], a[108:111], a[44:47], v[28:31]
    v_exp_f32 v21, v21
    v_smfmac_f32_16x16x64_bf16 v[56:59], v[16:19], v[44:51], v14
    v_cvt_pk_bf16_f32 v108, v20, v21
    v_mul_f32 v140, v118, v140
    v_mfma_f32_16x16x32_bf16 v[32:35], a[112:115], a[32:35], 0
    v_mul_f32 v141, v118, v141
    v_mul_f32 v142, v118, v142
    v_mul_f32 v143, v118, v143
    v_mfma_f32_16x16x32_bf16 v[32:35], a[116:119], a[36:39], v[32:35]
    v_exp_f32 v22, v22
    v_mfma_f32_16x16x32_bf16 v[32:35], a[120:123], a[40:43], v[32:35]
    v_cvt_pk_bf16_f32 v90, v140, v141
    v_cvt_pk_bf16_f32 v91, v142, v143
    v_mfma_f32_16x16x32_bf16 v[32:35], a[124:127], a[44:47], v[32:35]
    v_mul_f32 v156, v118, v156
    v_mul_f32 v157, v118, v157
    v_mul_f32 v158, v118, v158
    v_mfma_f32_16x16x32_bf16 v[160:163], a[128:131], v[36:39], v[160:163]
PG5:
    s_cbranch_vccnz BODY
    v_exp_f32 v23, v23
    v_mfma_f32_16x16x32_bf16 v[160:163], a[132:135], v[40:43], v[160:163]
    v_cvt_pk_bf16_f32 v109, v22, v23
    v_mul_f32 v159, v118, v159
    v_add_f32 v120, v56, v57
    v_mfma_f32_16x16x32_bf16 v[160:163], a[192:195], v[44:47], v[160:163]
    v_cvt_pk_bf16_f32 v98, v156, v157
    v_cvt_pk_bf16_f32 v99, v158, v159
    ds_write2st64_b64 v79, v[90:91], v[98:99] offset0:0 offset1:16
    v_rcp_f32 v122, v120
    v_mfma_f32_16x16x32_bf16 v[160:163], a[196:199], v[48:51], v[160:163]
    v_exp_f32 v24, v24
    v_mfma_f32_16x16x32_bf16 v[176:179], a[160:163], v[36:39], v[176:179]
    ds_read_b128 v[128:131], v8 offset:0
    ds_read_b128 v[132:135], v7 offset:512
    v_subrev_u32 v120, s35, v120
    v_mfma_f32_16x16x32_bf16 v[176:179], a[164:167], v[40:43], v[176:179]
    ds_read_b128 v[136:139], v8 offset:1024
    ds_read_b128 v[140:143], v7 offset:1536
    v_max_u32 v9, v9, v120
    v_mfma_f32_16x16x32_bf16 v[176:179], a[224:227], v[44:47], v[176:179]
    v_exp_f32 v25, v25
    v_mfma_f32_16x16x32_bf16 v[176:179], a[228:231], v[48:51], v[176:179]
    v_cvt_pk_bf16_f32 v110, v24, v25
    v_mul_f32 v160, v122, v160
    v_mfma_f32_16x16x32_bf16 v[164:167], a[136:139], v[36:39], v[164:167]
    v_mul_f32 v161, v122, v161
    v_mul_f32 v162, v122, v162
    v_mul_f32 v163, v122, v163
    v_mfma_f32_16x16x32_bf16 v[164:167], a[140:143], v[40:43], v[164:167]
    v_exp_f32 v26, v26
    v_mfma_f32_16x16x32_bf16 v[164:167], a[200:203], v[44:47], v[164:167]
    v_cvt_pk_bf16_f32 v84, v160, v161
    v_cvt_pk_bf16_f32 v85, v162, v163
    v_mfma_f32_16x16x32_bf16 v[164:167], a[204:207], v[48:51], v[164:167]
    v_mul_f32 v176, v122, v176
    v_mul_f32 v177, v122, v177
    v_mul_f32 v178, v122, v178
    v_mul_f32 v179, v122, v179
    v_mfma_f32_16x16x32_bf16 v[180:183], a[168:171], v[36:39], v[180:183]
    v_exp_f32 v27, v27
    v_mfma_f32_16x16x32_bf16 v[180:183], a[172:175], v[40:43], v[180:183]
    v_cvt_pk_bf16_f32 v111, v26, v27
    s_waitcnt lgkmcnt(3)
    buffer_store_dwordx4 v[128:131], v6, s[24:27], s37 offen offset:0 nt
    v_cvt_pk_bf16_f32 v92, v176, v177
    v_mfma_f32_16x16x32_bf16 v[180:183], a[232:235], v[44:47], v[180:183]
    s_waitcnt lgkmcnt(2)
    buffer_store_dwordx4 v[132:135], v6, s[24:27], s37 offen offset:1024 nt
    v_cvt_pk_bf16_f32 v93, v178, v179
    ds_write2st64_b64 v76, v[84:85], v[92:93] offset0:4 offset1:20
    v_mfma_f32_16x16x32_bf16 v[180:183], a[236:239], v[48:51], v[180:183]
    v_exp_f32 v28, v28
    v_mfma_f32_16x16x32_bf16 v[168:171], a[144:147], v[36:39], v[168:171]
    s_waitcnt lgkmcnt(2)
    buffer_store_dwordx4 v[136:139], v6, s[24:27], s37 offen offset:2048 nt
    v_mul_f32 v164, v122, v164
    v_mul_f32 v165, v122, v165
    v_mul_f32 v166, v122, v166
    v_mfma_f32_16x16x32_bf16 v[168:171], a[148:151], v[40:43], v[168:171]
    s_waitcnt lgkmcnt(1)
    buffer_store_dwordx4 v[140:143], v6, s[24:27], s37 offen offset:3072 nt
    v_mul_f32 v167, v122, v167
    v_cvt_pk_bf16_f32 v86, v164, v165
    v_cvt_pk_bf16_f32 v87, v166, v167
    v_mfma_f32_16x16x32_bf16 v[168:171], a[208:211], v[44:47], v[168:171]
    v_exp_f32 v29, v29
    v_mfma_f32_16x16x32_bf16 v[168:171], a[212:215], v[48:51], v[168:171]
    v_cvt_pk_bf16_f32 v112, v28, v29
    s_add_u32 s37, s37, 4096
    v_mul_f32 v180, v122, v180
    v_mfma_f32_16x16x32_bf16 v[184:187], a[176:179], v[36:39], v[184:187]
    v_mul_f32 v181, v122, v181
    v_mul_f32 v182, v122, v182
    v_mul_f32 v183, v122, v183
    v_mfma_f32_16x16x32_bf16 v[184:187], a[180:183], v[40:43], v[184:187]
    v_exp_f32 v30, v30
    v_mfma_f32_16x16x32_bf16 v[184:187], a[240:243], v[44:47], v[184:187]
    v_cvt_pk_bf16_f32 v94, v180, v181
    v_cvt_pk_bf16_f32 v95, v182, v183
    ds_write2st64_b64 v77, v[86:87], v[94:95] offset0:4 offset1:20
    v_mfma_f32_16x16x32_bf16 v[184:187], a[244:247], v[48:51], v[184:187]
    v_mul_f32 v168, v122, v168
    v_mul_f32 v169, v122, v169
    v_mfma_f32_16x16x32_bf16 v[172:175], a[152:155], v[36:39], v[172:175]
    v_exp_f32 v31, v31
    v_mfma_f32_16x16x32_bf16 v[172:175], a[156:159], v[40:43], v[172:175]
    v_cvt_pk_bf16_f32 v113, v30, v31
    v_mul_f32 v170, v122, v170
    v_mul_f32 v171, v122, v171
    v_mfma_f32_16x16x32_bf16 v[172:175], a[216:219], v[44:47], v[172:175]
    v_cvt_pk_bf16_f32 v88, v168, v169
    v_cvt_pk_bf16_f32 v89, v170, v171
    v_mfma_f32_16x16x32_bf16 v[172:175], a[220:223], v[48:51], v[172:175]
    v_exp_f32 v32, v32
    v_mfma_f32_16x16x32_bf16 v[188:191], a[184:187], v[36:39], v[188:191]
    v_mul_f32 v184, v122, v184
    v_mul_f32 v185, v122, v185
    v_mul_f32 v186, v122, v186
    v_mfma_f32_16x16x32_bf16 v[188:191], a[188:191], v[40:43], v[188:191]
    v_mul_f32 v187, v122, v187
    v_cvt_pk_bf16_f32 v96, v184, v185
    v_cvt_pk_bf16_f32 v97, v186, v187
    ds_write2st64_b64 v78, v[88:89], v[96:97] offset0:4 offset1:20
    v_mfma_f32_16x16x32_bf16 v[188:191], a[248:251], v[44:47], v[188:191]
    v_exp_f32 v33, v33
    v_mfma_f32_16x16x32_bf16 v[188:191], a[252:255], v[48:51], v[188:191]
    v_cvt_pk_bf16_f32 v114, v32, v33
    v_mul_f32 v172, v122, v172
    v_smfmac_f32_16x16x64_bf16 v[60:63], v[16:19], v[68:75], v14
    v_mul_f32 v173, v122, v173
    v_mul_f32 v174, v122, v174
    v_mul_f32 v175, v122, v175
    v_mfma_f32_16x16x32_bf16 v[20:23], a[64:67], a[48:51], 0
    v_exp_f32 v34, v34
    v_mfma_f32_16x16x32_bf16 v[20:23], a[68:71], a[52:55], v[20:23]
    v_cvt_pk_bf16_f32 v90, v172, v173
    v_cvt_pk_bf16_f32 v91, v174, v175
    v_mfma_f32_16x16x32_bf16 v[20:23], a[72:75], a[56:59], v[20:23]
    v_mul_f32 v188, v122, v188
    v_mul_f32 v189, v122, v189
    v_mul_f32 v190, v122, v190
    v_mfma_f32_16x16x32_bf16 v[20:23], a[76:79], a[60:63], v[20:23]
    v_exp_f32 v35, v35
    v_mfma_f32_16x16x32_bf16 v[24:27], a[80:83], a[48:51], 0
    v_cvt_pk_bf16_f32 v115, v34, v35
    v_mul_f32 v191, v122, v191
    v_mfma_f32_16x16x32_bf16 v[24:27], a[84:87], a[52:55], v[24:27]
    v_cvt_pk_bf16_f32 v98, v188, v189
    v_cvt_pk_bf16_f32 v99, v190, v191
    ds_write2st64_b64 v79, v[90:91], v[98:99] offset0:4 offset1:20
    v_mfma_f32_16x16x32_bf16 v[24:27], a[88:91], a[56:59], v[24:27]
    ds_read_b128 v[160:163], v8 offset:2048
    ds_read_b128 v[164:167], v7 offset:2560
    v_mfma_f32_16x16x32_bf16 v[24:27], a[92:95], a[60:63], v[24:27]
    ds_read_b128 v[168:171], v8 offset:3072
    ds_read_b128 v[172:175], v7 offset:3584
    v_mfma_f32_16x16x32_bf16 v[28:31], a[96:99], a[48:51], 0
    v_exp_f32 v20, v20
    v_mfma_f32_16x16x32_bf16 v[28:31], a[100:103], a[52:55], v[28:31]
    v_mfma_f32_16x16x32_bf16 v[28:31], a[104:107], a[56:59], v[28:31]
    v_exp_f32 v21, v21
    v_mfma_f32_16x16x32_bf16 v[28:31], a[108:111], a[60:63], v[28:31]
    v_cvt_pk_bf16_f32 v36, v20, v21
    v_smfmac_f32_16x16x64_bf16 v[60:63], v[16:19], v[108:115], v14
    v_exp_f32 v22, v22
    v_mfma_f32_16x16x32_bf16 v[32:35], a[112:115], a[48:51], 0
    v_mfma_f32_16x16x32_bf16 v[32:35], a[116:119], a[52:55], v[32:35]
    v_exp_f32 v23, v23
    v_mfma_f32_16x16x32_bf16 v[32:35], a[120:123], a[56:59], v[32:35]
    v_cvt_pk_bf16_f32 v37, v22, v23
    s_waitcnt lgkmcnt(3)
    buffer_store_dwordx4 v[160:163], v6, s[24:27], s37 offen offset:0 nt
    v_mfma_f32_16x16x32_bf16 v[32:35], a[124:127], a[60:63], v[32:35]
    s_waitcnt lgkmcnt(2)
    buffer_store_dwordx4 v[164:167], v6, s[24:27], s37 offen offset:1024 nt
    v_smfmac_f32_16x16x64_bf16 v[64:67], v[16:19], v[100:107], v14
    v_exp_f32 v24, v24
    v_mfma_f32_16x16x32_bf16 v[192:195], a[128:131], v[68:71], v[192:195]
    s_waitcnt lgkmcnt(1)
    buffer_store_dwordx4 v[168:171], v6, s[24:27], s37 offen offset:2048 nt
    v_mfma_f32_16x16x32_bf16 v[192:195], a[132:135], v[72:75], v[192:195]
    v_exp_f32 v25, v25
    v_mfma_f32_16x16x32_bf16 v[192:195], a[192:195], v[108:111], v[192:195]
    v_cvt_pk_bf16_f32 v38, v24, v25
    s_waitcnt lgkmcnt(0)
    buffer_store_dwordx4 v[172:175], v6, s[24:27], s37 offen offset:3072 nt
    v_add_f32 v116, v60, v61
    v_mfma_f32_16x16x32_bf16 v[192:195], a[196:199], v[112:115], v[192:195]
    v_exp_f32 v26, v26
    v_mfma_f32_16x16x32_bf16 v[208:211], a[160:163], v[68:71], v[208:211]
    s_add_u32 s37, s37, 4096
    v_rcp_f32 v118, v116
    v_mfma_f32_16x16x32_bf16 v[208:211], a[164:167], v[72:75], v[208:211]
    v_exp_f32 v27, v27
    v_mfma_f32_16x16x32_bf16 v[208:211], a[224:227], v[108:111], v[208:211]
    v_cvt_pk_bf16_f32 v39, v26, v27
    v_subrev_u32 v116, s35, v116
    v_max_u32 v9, v9, v116
    v_mfma_f32_16x16x32_bf16 v[208:211], a[228:231], v[112:115], v[208:211]
    v_mul_f32 v192, v118, v192
    v_mul_f32 v193, v118, v193
    v_mul_f32 v194, v118, v194
    v_mfma_f32_16x16x32_bf16 v[196:199], a[136:139], v[68:71], v[196:199]
    v_exp_f32 v28, v28
    v_mfma_f32_16x16x32_bf16 v[196:199], a[140:143], v[72:75], v[196:199]
    v_mul_f32 v195, v118, v195
    v_cvt_pk_bf16_f32 v84, v192, v193
    v_cvt_pk_bf16_f32 v85, v194, v195
    v_mfma_f32_16x16x32_bf16 v[196:199], a[200:203], v[108:111], v[196:199]
    v_exp_f32 v29, v29
    v_mfma_f32_16x16x32_bf16 v[196:199], a[204:207], v[112:115], v[196:199]
    v_cvt_pk_bf16_f32 v40, v28, v29
    v_mul_f32 v208, v118, v208
    v_mul_f32 v209, v118, v209
    v_mul_f32 v210, v118, v210
    v_mfma_f32_16x16x32_bf16 v[212:215], a[168:171], v[68:71], v[212:215]
    v_exp_f32 v30, v30
    v_mfma_f32_16x16x32_bf16 v[212:215], a[172:175], v[72:75], v[212:215]
    v_mul_f32 v211, v118, v211
    v_cvt_pk_bf16_f32 v92, v208, v209
    v_cvt_pk_bf16_f32 v93, v210, v211
    ds_write2st64_b64 v76, v[84:85], v[92:93] offset0:8 offset1:24
    v_mfma_f32_16x16x32_bf16 v[212:215], a[232:235], v[108:111], v[212:215]
    v_exp_f32 v31, v31
    v_mfma_f32_16x16x32_bf16 v[212:215], a[236:239], v[112:115], v[212:215]
    v_cvt_pk_bf16_f32 v41, v30, v31
    v_mul_f32 v196, v118, v196
    v_mfma_f32_16x16x32_bf16 v[200:203], a[144:147], v[68:71], v[200:203]
    v_mul_f32 v197, v118, v197
    v_mul_f32 v198, v118, v198
    v_mul_f32 v199, v118, v199
    v_mfma_f32_16x16x32_bf16 v[200:203], a[148:151], v[72:75], v[200:203]
    v_exp_f32 v32, v32
    v_mfma_f32_16x16x32_bf16 v[200:203], a[208:211], v[108:111], v[200:203]
    v_cvt_pk_bf16_f32 v86, v196, v197
    v_cvt_pk_bf16_f32 v87, v198, v199
    v_mfma_f32_16x16x32_bf16 v[200:203], a[212:215], v[112:115], v[200:203]
    v_exp_f32 v33, v33
    v_mfma_f32_16x16x32_bf16 v[216:219], a[176:179], v[68:71], v[216:219]
    v_cvt_pk_bf16_f32 v42, v32, v33
    v_mul_f32 v212, v118, v212
    v_mul_f32 v213, v118, v213
    v_mul_f32 v214, v118, v214
    v_mfma_f32_16x16x32_bf16 v[216:219], a[180:183], v[72:75], v[216:219]
    v_exp_f32 v34, v34
    v_mfma_f32_16x16x32_bf16 v[216:219], a[240:243], v[108:111], v[216:219]
    v_mul_f32 v215, v118, v215
    v_cvt_pk_bf16_f32 v94, v212, v213
    v_cvt_pk_bf16_f32 v95, v214, v215
    ds_write2st64_b64 v77, v[86:87], v[94:95] offset0:8 offset1:24
    v_mfma_f32_16x16x32_bf16 v[216:219], a[244:247], v[112:115], v[216:219]
    v_exp_f32 v35, v35
    v_mfma_f32_16x16x32_bf16 v[204:207], a[152:155], v[68:71], v[204:207]
    v_cvt_pk_bf16_f32 v43, v34, v35
    v_mul_f32 v200, v118, v200
    v_mfma_f32_16x16x32_bf16 v[204:207], a[156:159], v[72:75], v[204:207]
    v_mul_f32 v201, v118, v201
    v_mul_f32 v202, v118, v202
    v_mul_f32 v203, v118, v203
    v_mfma_f32_16x16x32_bf16 v[204:207], a[216:219], v[108:111], v[204:207]
    v_cvt_pk_bf16_f32 v88, v200, v201
    v_cvt_pk_bf16_f32 v89, v202, v203
    v_mfma_f32_16x16x32_bf16 v[204:207], a[220:223], v[112:115], v[204:207]
    v_mul_f32 v216, v118, v216
    v_mul_f32 v217, v118, v217
    v_smfmac_f32_16x16x64_bf16 v[64:67], v[16:19], v[36:43], v14
    v_mul_f32 v218, v118, v218
    v_mul_f32 v219, v118, v219
    v_mfma_f32_16x16x32_bf16 v[220:223], a[184:187], v[68:71], v[220:223]
    v_cvt_pk_bf16_f32 v96, v216, v217
    v_cvt_pk_bf16_f32 v97, v218, v219
    v_mfma_f32_16x16x32_bf16 v[220:223], a[188:191], v[72:75], v[220:223]
    ds_write2st64_b64 v78, v[88:89], v[96:97] offset0:8 offset1:24
    v_mfma_f32_16x16x32_bf16 v[220:223], a[248:251], v[108:111], v[220:223]
    v_mul_f32 v204, v118, v204
    v_mul_f32 v205, v118, v205
    v_mfma_f32_16x16x32_bf16 v[220:223], a[252:255], v[112:115], v[220:223]
    v_mul_f32 v206, v118, v206
    v_mfma_f32_16x16x32_bf16 v[224:227], a[128:131], v[100:103], v[224:227]
    v_mul_f32 v207, v118, v207
    v_cvt_pk_bf16_f32 v90, v204, v205
    v_mfma_f32_16x16x32_bf16 v[224:227], a[132:135], v[104:107], v[224:227]
    v_cvt_pk_bf16_f32 v91, v206, v207
    v_add_f32 v120, v64, v65
    v_mfma_f32_16x16x32_bf16 v[224:227], a[192:195], v[36:39], v[224:227]
    v_rcp_f32 v122, v120
    v_mfma_f32_16x16x32_bf16 v[224:227], a[196:199], v[40:43], v[224:227]
    v_mul_f32 v220, v118, v220
    v_mul_f32 v221, v118, v221
    v_mfma_f32_16x16x32_bf16 v[240:243], a[160:163], v[100:103], v[240:243]
    v_mul_f32 v222, v118, v222
    v_mul_f32 v223, v118, v223
    v_subrev_u32 v120, s35, v120
    v_mfma_f32_16x16x32_bf16 v[240:243], a[164:167], v[104:107], v[240:243]
    v_cvt_pk_bf16_f32 v98, v220, v221
    v_cvt_pk_bf16_f32 v99, v222, v223
    v_mfma_f32_16x16x32_bf16 v[240:243], a[224:227], v[36:39], v[240:243]
    ds_write2st64_b64 v79, v[90:91], v[98:99] offset0:8 offset1:24
    v_max_u32 v9, v9, v120
    v_mfma_f32_16x16x32_bf16 v[240:243], a[228:231], v[40:43], v[240:243]
    ds_read_b128 v[192:195], v8 offset:4096
    ds_read_b128 v[196:199], v7 offset:4608
    v_mfma_f32_16x16x32_bf16 v[228:231], a[136:139], v[100:103], v[228:231]
    ds_read_b128 v[200:203], v8 offset:5120
    v_mul_f32 v224, v122, v224
    v_mul_f32 v225, v122, v225
    v_mfma_f32_16x16x32_bf16 v[228:231], a[140:143], v[104:107], v[228:231]
    ds_read_b128 v[204:207], v7 offset:5632
    v_mul_f32 v226, v122, v226
    v_mfma_f32_16x16x32_bf16 v[228:231], a[200:203], v[36:39], v[228:231]
    v_mul_f32 v227, v122, v227
    v_cvt_pk_bf16_f32 v84, v224, v225
    v_cvt_pk_bf16_f32 v85, v226, v227
    v_mfma_f32_16x16x32_bf16 v[228:231], a[204:207], v[40:43], v[228:231]
    v_mul_f32 v240, v122, v240
    v_mul_f32 v241, v122, v241
    v_mfma_f32_16x16x32_bf16 v[244:247], a[168:171], v[100:103], v[244:247]
    v_mul_f32 v242, v122, v242
    v_mul_f32 v243, v122, v243
    v_mfma_f32_16x16x32_bf16 v[244:247], a[172:175], v[104:107], v[244:247]
    v_cvt_pk_bf16_f32 v92, v240, v241
    v_cvt_pk_bf16_f32 v93, v242, v243
    v_mfma_f32_16x16x32_bf16 v[244:247], a[232:235], v[36:39], v[244:247]
    ds_write2st64_b64 v76, v[84:85], v[92:93] offset0:12 offset1:28
    v_mfma_f32_16x16x32_bf16 v[244:247], a[236:239], v[40:43], v[244:247]
    v_mul_f32 v228, v122, v228
    v_mul_f32 v229, v122, v229
    v_mfma_f32_16x16x32_bf16 v[232:235], a[144:147], v[100:103], v[232:235]
    s_waitcnt lgkmcnt(4)
    buffer_store_dwordx4 v[192:195], v6, s[24:27], s37 offen offset:0 nt
    v_mul_f32 v230, v122, v230
    v_mfma_f32_16x16x32_bf16 v[232:235], a[148:151], v[104:107], v[232:235]
    s_waitcnt lgkmcnt(3)
    buffer_store_dwordx4 v[196:199], v6, s[24:27], s37 offen offset:1024 nt
    v_mfma_f32_16x16x32_bf16 v[232:235], a[208:211], v[36:39], v[232:235]
    v_mul_f32 v231, v122, v231
    v_cvt_pk_bf16_f32 v86, v228, v229
    v_cvt_pk_bf16_f32 v87, v230, v231
    v_mfma_f32_16x16x32_bf16 v[232:235], a[212:215], v[40:43], v[232:235]
    s_waitcnt lgkmcnt(2)
    buffer_store_dwordx4 v[200:203], v6, s[24:27], s37 offen offset:2048 nt
    v_mul_f32 v244, v122, v244
    v_mfma_f32_16x16x32_bf16 v[248:251], a[176:179], v[100:103], v[248:251]
    v_mul_f32 v245, v122, v245
    v_mul_f32 v246, v122, v246
    v_mfma_f32_16x16x32_bf16 v[248:251], a[180:183], v[104:107], v[248:251]
    s_waitcnt lgkmcnt(1)
    buffer_store_dwordx4 v[204:207], v6, s[24:27], s37 offen offset:3072 nt
    v_mul_f32 v247, v122, v247
    v_mfma_f32_16x16x32_bf16 v[248:251], a[240:243], v[36:39], v[248:251]
    v_cvt_pk_bf16_f32 v94, v244, v245
    v_cvt_pk_bf16_f32 v95, v246, v247
    ds_write2st64_b64 v77, v[86:87], v[94:95] offset0:12 offset1:28
    v_mfma_f32_16x16x32_bf16 v[248:251], a[244:247], v[40:43], v[248:251]
    s_add_u32 s37, s37, 4096
    v_mul_f32 v232, v122, v232
    v_mfma_f32_16x16x32_bf16 v[236:239], a[152:155], v[100:103], v[236:239]
    v_mul_f32 v233, v122, v233
    v_mul_f32 v234, v122, v234
    v_mfma_f32_16x16x32_bf16 v[236:239], a[156:159], v[104:107], v[236:239]
    v_mul_f32 v235, v122, v235
    v_cvt_pk_bf16_f32 v88, v232, v233
    v_mfma_f32_16x16x32_bf16 v[236:239], a[216:219], v[36:39], v[236:239]
    v_cvt_pk_bf16_f32 v89, v234, v235
    v_mfma_f32_16x16x32_bf16 v[236:239], a[220:223], v[40:43], v[236:239]
    v_mul_f32 v248, v122, v248
    v_mul_f32 v249, v122, v249
    v_mfma_f32_16x16x32_bf16 v[252:255], a[184:187], v[100:103], v[252:255]
    v_mul_f32 v250, v122, v250
    v_mul_f32 v251, v122, v251
    v_mfma_f32_16x16x32_bf16 v[252:255], a[188:191], v[104:107], v[252:255]
    v_cvt_pk_bf16_f32 v96, v248, v249
    v_cvt_pk_bf16_f32 v97, v250, v251
    v_mfma_f32_16x16x32_bf16 v[252:255], a[248:251], v[36:39], v[252:255]
    ds_write2st64_b64 v78, v[88:89], v[96:97] offset0:12 offset1:28
    v_mfma_f32_16x16x32_bf16 v[252:255], a[252:255], v[40:43], v[252:255]
    v_pk_mul_f32 v[236:237], v[236:237], v[122:123] op_sel_hi:[1,0]
    v_pk_mul_f32 v[238:239], v[238:239], v[122:123] op_sel_hi:[1,0]
    v_cvt_pk_bf16_f32 v90, v236, v237
    v_cvt_pk_bf16_f32 v91, v238, v239
    s_nop 3
    v_pk_mul_f32 v[252:253], v[252:253], v[122:123] op_sel_hi:[1,0]
    v_pk_mul_f32 v[254:255], v[254:255], v[122:123] op_sel_hi:[1,0]
    v_cvt_pk_bf16_f32 v98, v252, v253
    v_cvt_pk_bf16_f32 v99, v254, v255
    ds_write2st64_b64 v79, v[90:91], v[98:99] offset0:12 offset1:28
    ds_read_b128 v[224:227], v8 offset:6144
    ds_read_b128 v[228:231], v7 offset:6656
    ds_read_b128 v[232:235], v8 offset:7168
    ds_read_b128 v[236:239], v7 offset:7680
    v_cmp_lt_u32 vcc, 0x20000000, v9
    s_waitcnt lgkmcnt(3)
    buffer_store_dwordx4 v[224:227], v6, s[24:27], s37 offen offset:0 nt
    s_waitcnt lgkmcnt(2)
    buffer_store_dwordx4 v[228:231], v6, s[24:27], s37 offen offset:1024 nt
    s_waitcnt lgkmcnt(1)
    buffer_store_dwordx4 v[232:235], v6, s[24:27], s37 offen offset:2048 nt
    s_waitcnt lgkmcnt(0)
    buffer_store_dwordx4 v[236:239], v6, s[24:27], s37 offen offset:3072 nt
    s_add_u32 s37, s37, 4096
    s_cbranch_vccnz FALLBACK
END:
    s_endpgm
FALLBACK:
    s_waitcnt vmcnt(0) lgkmcnt(0)
    s_lshl_b32 s46, s39, 12
    s_lshl_b32 s47, s39, 14
    v_subrev_u32 v10, s46, v10
    v_subrev_u32 v11, s46, v11
    v_subrev_u32 v12, s46, v12
    v_subrev_u32 v13, s46, v13
    v_and_b32 v3, 0x3fff, v3
    v_add_u32 v3, s47, v3
    v_and_b32 v4, 0x3fff, v4
    v_add_u32 v4, s47, v4
    s_mov_b32 s37, 0
    s_mov_b32 s33, 0
FB_BLK:
    s_add_u32 s45, s37, s47
    s_add_u32 m0, s47, 0
    s_add_u32 s44, s45, 0
    buffer_load_dwordx4 v10, s[12:15], s44 offen offset:0 lds
    buffer_load_dwordx4 v11, s[12:15], s44 offen offset:1024 lds
    buffer_load_dwordx4 v12, s[12:15], s44 offen offset:2048 lds
    buffer_load_dwordx4 v13, s[12:15], s44 offen offset:3072 lds
    s_add_u32 m0, s47, 4096
    s_add_u32 s44, s45, 4096
    buffer_load_dwordx4 v10, s[12:15], s44 offen offset:0 lds
    buffer_load_dwordx4 v11, s[12:15], s44 offen offset:1024 lds
    buffer_load_dwordx4 v12, s[12:15], s44 offen offset:2048 lds
    buffer_load_dwordx4 v13, s[12:15], s44 offen offset:3072 lds
    s_add_u32 m0, s47, 8192
    s_add_u32 s44, s45, 8192
    buffer_load_dwordx4 v10, s[12:15], s44 offen offset:0 lds
    buffer_load_dwordx4 v11, s[12:15], s44 offen offset:1024 lds
    buffer_load_dwordx4 v12, s[12:15], s44 offen offset:2048 lds
    buffer_load_dwordx4 v13, s[12:15], s44 offen offset:3072 lds
    s_add_u32 m0, s47, 12288
    s_add_u32 s44, s45, 12288
    buffer_load_dwordx4 v10, s[12:15], s44 offen offset:0 lds
    buffer_load_dwordx4 v11, s[12:15], s44 offen offset:1024 lds
    buffer_load_dwordx4 v12, s[12:15], s44 offen offset:2048 lds
    buffer_load_dwordx4 v13, s[12:15], s44 offen offset:3072 lds
    s_waitcnt vmcnt(0)
    ds_read_b128 a[0:3], v5 offset:0
    ds_read_b128 a[4:7], v5 offset:256
    ds_read_b128 a[8:11], v5 offset:512
    ds_read_b128 a[12:15], v5 offset:768
    s_waitcnt lgkmcnt(0)
    ds_read_b128 a[16:19], v5 offset:4096
    ds_read_b128 a[20:23], v5 offset:4352
    ds_read_b128 a[24:27], v5 offset:4608
    ds_read_b128 a[28:31], v5 offset:4864
    s_waitcnt lgkmcnt(0)
    ds_read_b128 a[32:35], v5 offset:8192
    ds_read_b128 a[36:39], v5 offset:8448
    ds_read_b128 a[40:43], v5 offset:8704
    ds_read_b128 a[44:47], v5 offset:8960
    s_waitcnt lgkmcnt(0)
    ds_read_b128 a[48:51], v5 offset:12288
    ds_read_b128 a[52:55], v5 offset:12544
    ds_read_b128 a[56:59], v5 offset:12800
    ds_read_b128 a[60:63], v5 offset:13056
    s_waitcnt lgkmcnt(0)
    v_mov_b32 v68, 0xff800000
    v_mov_b32 v69, 0xff800000
    v_mov_b32 v70, 0xff800000
    v_mov_b32 v71, 0xff800000
    s_mov_b32 s29, s33
    s_add_u32 s33, s33, 262144
FB_P1:
    s_add_u32 m0, s47, 0
    s_add_u32 s44, s29, 0
    buffer_load_dwordx4 v10, s[16:19], s44 offen offset:0 lds
    buffer_load_dwordx4 v11, s[16:19], s44 offen offset:1024 lds
    buffer_load_dwordx4 v12, s[16:19], s44 offen offset:2048 lds
    buffer_load_dwordx4 v13, s[16:19], s44 offen offset:3072 lds
    s_add_u32 m0, s47, 4096
    s_add_u32 s44, s29, 4096
    buffer_load_dwordx4 v10, s[16:19], s44 offen offset:0 lds
    buffer_load_dwordx4 v11, s[16:19], s44 offen offset:1024 lds
    buffer_load_dwordx4 v12, s[16:19], s44 offen offset:2048 lds
    buffer_load_dwordx4 v13, s[16:19], s44 offen offset:3072 lds
    s_add_u32 m0, s47, 8192
    s_add_u32 s44, s29, 8192
    buffer_load_dwordx4 v10, s[16:19], s44 offen offset:0 lds
    buffer_load_dwordx4 v11, s[16:19], s44 offen offset:1024 lds
    buffer_load_dwordx4 v12, s[16:19], s44 offen offset:2048 lds
    buffer_load_dwordx4 v13, s[16:19], s44 offen offset:3072 lds
    s_add_u32 m0, s47, 12288
    s_add_u32 s44, s29, 12288
    buffer_load_dwordx4 v10, s[16:19], s44 offen offset:0 lds
    buffer_load_dwordx4 v11, s[16:19], s44 offen offset:1024 lds
    buffer_load_dwordx4 v12, s[16:19], s44 offen offset:2048 lds
    buffer_load_dwordx4 v13, s[16:19], s44 offen offset:3072 lds
    s_waitcnt vmcnt(0)
    ds_read_b128 a[64:67], v5 offset:0
    ds_read_b128 a[68:71], v5 offset:256
    ds_read_b128 a[72:75], v5 offset:512
    ds_read_b128 a[76:79], v5 offset:768
    ds_read_b128 a[80:83], v5 offset:4096
    ds_read_b128 a[84:87], v5 offset:4352
    ds_read_b128 a[88:91], v5 offset:4608
    ds_read_b128 a[92:95], v5 offset:4864
    s_waitcnt lgkmcnt(0)
    ds_read_b128 a[96:99], v5 offset:8192
    ds_read_b128 a[100:103], v5 offset:8448
    ds_read_b128 a[104:107], v5 offset:8704
    ds_read_b128 a[108:111], v5 offset:8960
    ds_read_b128 a[112:115], v5 offset:12288
    ds_read_b128 a[116:119], v5 offset:12544
    ds_read_b128 a[120:123], v5 offset:12800
    ds_read_b128 a[124:127], v5 offset:13056
    s_waitcnt lgkmcnt(0)
    v_mfma_f32_16x16x32_bf16 v[20:23], a[64:67], a[0:3], 0
    v_mfma_f32_16x16x32_bf16 v[20:23], a[68:71], a[4:7], v[20:23]
    v_mfma_f32_16x16x32_bf16 v[20:23], a[72:75], a[8:11], v[20:23]
    v_mfma_f32_16x16x32_bf16 v[20:23], a[76:79], a[12:15], v[20:23]
    v_mfma_f32_16x16x32_bf16 v[24:27], a[80:83], a[0:3], 0
    v_mfma_f32_16x16x32_bf16 v[24:27], a[84:87], a[4:7], v[24:27]
    v_mfma_f32_16x16x32_bf16 v[24:27], a[88:91], a[8:11], v[24:27]
    v_mfma_f32_16x16x32_bf16 v[24:27], a[92:95], a[12:15], v[24:27]
    v_mfma_f32_16x16x32_bf16 v[28:31], a[96:99], a[0:3], 0
    v_mfma_f32_16x16x32_bf16 v[28:31], a[100:103], a[4:7], v[28:31]
    v_mfma_f32_16x16x32_bf16 v[28:31], a[104:107], a[8:11], v[28:31]
    v_mfma_f32_16x16x32_bf16 v[28:31], a[108:111], a[12:15], v[28:31]
    v_mfma_f32_16x16x32_bf16 v[32:35], a[112:115], a[0:3], 0
    v_mfma_f32_16x16x32_bf16 v[32:35], a[116:119], a[4:7], v[32:35]
    v_mfma_f32_16x16x32_bf16 v[32:35], a[120:123], a[8:11], v[32:35]
    v_mfma_f32_16x16x32_bf16 v[32:35], a[124:127], a[12:15], v[32:35]
    s_nop 7
    v_max3_f32 v68, v68, v20, v21
    v_max3_f32 v68, v68, v22, v23
    v_max3_f32 v68, v68, v24, v25
    v_max3_f32 v68, v68, v26, v27
    v_max3_f32 v68, v68, v28, v29
    v_max3_f32 v68, v68, v30, v31
    v_max3_f32 v68, v68, v32, v33
    v_max3_f32 v68, v68, v34, v35
    s_nop 1
    v_mfma_f32_16x16x32_bf16 v[20:23], a[64:67], a[16:19], 0
    v_mfma_f32_16x16x32_bf16 v[20:23], a[68:71], a[20:23], v[20:23]
    v_mfma_f32_16x16x32_bf16 v[20:23], a[72:75], a[24:27], v[20:23]
    v_mfma_f32_16x16x32_bf16 v[20:23], a[76:79], a[28:31], v[20:23]
    v_mfma_f32_16x16x32_bf16 v[24:27], a[80:83], a[16:19], 0
    v_mfma_f32_16x16x32_bf16 v[24:27], a[84:87], a[20:23], v[24:27]
    v_mfma_f32_16x16x32_bf16 v[24:27], a[88:91], a[24:27], v[24:27]
    v_mfma_f32_16x16x32_bf16 v[24:27], a[92:95], a[28:31], v[24:27]
    v_mfma_f32_16x16x32_bf16 v[28:31], a[96:99], a[16:19], 0
    v_mfma_f32_16x16x32_bf16 v[28:31], a[100:103], a[20:23], v[28:31]
    v_mfma_f32_16x16x32_bf16 v[28:31], a[104:107], a[24:27], v[28:31]
    v_mfma_f32_16x16x32_bf16 v[28:31], a[108:111], a[28:31], v[28:31]
    v_mfma_f32_16x16x32_bf16 v[32:35], a[112:115], a[16:19], 0
    v_mfma_f32_16x16x32_bf16 v[32:35], a[116:119], a[20:23], v[32:35]
    v_mfma_f32_16x16x32_bf16 v[32:35], a[120:123], a[24:27], v[32:35]
    v_mfma_f32_16x16x32_bf16 v[32:35], a[124:127], a[28:31], v[32:35]
    s_nop 7
    v_max3_f32 v69, v69, v20, v21
    v_max3_f32 v69, v69, v22, v23
    v_max3_f32 v69, v69, v24, v25
    v_max3_f32 v69, v69, v26, v27
    v_max3_f32 v69, v69, v28, v29
    v_max3_f32 v69, v69, v30, v31
    v_max3_f32 v69, v69, v32, v33
    v_max3_f32 v69, v69, v34, v35
    s_nop 1
    v_mfma_f32_16x16x32_bf16 v[20:23], a[64:67], a[32:35], 0
    v_mfma_f32_16x16x32_bf16 v[20:23], a[68:71], a[36:39], v[20:23]
    v_mfma_f32_16x16x32_bf16 v[20:23], a[72:75], a[40:43], v[20:23]
    v_mfma_f32_16x16x32_bf16 v[20:23], a[76:79], a[44:47], v[20:23]
    v_mfma_f32_16x16x32_bf16 v[24:27], a[80:83], a[32:35], 0
    v_mfma_f32_16x16x32_bf16 v[24:27], a[84:87], a[36:39], v[24:27]
    v_mfma_f32_16x16x32_bf16 v[24:27], a[88:91], a[40:43], v[24:27]
    v_mfma_f32_16x16x32_bf16 v[24:27], a[92:95], a[44:47], v[24:27]
    v_mfma_f32_16x16x32_bf16 v[28:31], a[96:99], a[32:35], 0
    v_mfma_f32_16x16x32_bf16 v[28:31], a[100:103], a[36:39], v[28:31]
    v_mfma_f32_16x16x32_bf16 v[28:31], a[104:107], a[40:43], v[28:31]
    v_mfma_f32_16x16x32_bf16 v[28:31], a[108:111], a[44:47], v[28:31]
    v_mfma_f32_16x16x32_bf16 v[32:35], a[112:115], a[32:35], 0
    v_mfma_f32_16x16x32_bf16 v[32:35], a[116:119], a[36:39], v[32:35]
    v_mfma_f32_16x16x32_bf16 v[32:35], a[120:123], a[40:43], v[32:35]
    v_mfma_f32_16x16x32_bf16 v[32:35], a[124:127], a[44:47], v[32:35]
    s_nop 7
    v_max3_f32 v70, v70, v20, v21
    v_max3_f32 v70, v70, v22, v23
    v_max3_f32 v70, v70, v24, v25
    v_max3_f32 v70, v70, v26, v27
    v_max3_f32 v70, v70, v28, v29
    v_max3_f32 v70, v70, v30, v31
    v_max3_f32 v70, v70, v32, v33
    v_max3_f32 v70, v70, v34, v35
    s_nop 1
    v_mfma_f32_16x16x32_bf16 v[20:23], a[64:67], a[48:51], 0
    v_mfma_f32_16x16x32_bf16 v[20:23], a[68:71], a[52:55], v[20:23]
    v_mfma_f32_16x16x32_bf16 v[20:23], a[72:75], a[56:59], v[20:23]
    v_mfma_f32_16x16x32_bf16 v[20:23], a[76:79], a[60:63], v[20:23]
    v_mfma_f32_16x16x32_bf16 v[24:27], a[80:83], a[48:51], 0
    v_mfma_f32_16x16x32_bf16 v[24:27], a[84:87], a[52:55], v[24:27]
    v_mfma_f32_16x16x32_bf16 v[24:27], a[88:91], a[56:59], v[24:27]
    v_mfma_f32_16x16x32_bf16 v[24:27], a[92:95], a[60:63], v[24:27]
    v_mfma_f32_16x16x32_bf16 v[28:31], a[96:99], a[48:51], 0
    v_mfma_f32_16x16x32_bf16 v[28:31], a[100:103], a[52:55], v[28:31]
    v_mfma_f32_16x16x32_bf16 v[28:31], a[104:107], a[56:59], v[28:31]
    v_mfma_f32_16x16x32_bf16 v[28:31], a[108:111], a[60:63], v[28:31]
    v_mfma_f32_16x16x32_bf16 v[32:35], a[112:115], a[48:51], 0
    v_mfma_f32_16x16x32_bf16 v[32:35], a[116:119], a[52:55], v[32:35]
    v_mfma_f32_16x16x32_bf16 v[32:35], a[120:123], a[56:59], v[32:35]
    v_mfma_f32_16x16x32_bf16 v[32:35], a[124:127], a[60:63], v[32:35]
    s_nop 7
    v_max3_f32 v71, v71, v20, v21
    v_max3_f32 v71, v71, v22, v23
    v_max3_f32 v71, v71, v24, v25
    v_max3_f32 v71, v71, v26, v27
    v_max3_f32 v71, v71, v28, v29
    v_max3_f32 v71, v71, v30, v31
    v_max3_f32 v71, v71, v32, v33
    v_max3_f32 v71, v71, v34, v35
    s_nop 1
    s_add_u32 s29, s29, 16384
    s_cmp_lt_u32 s29, s33
    s_cbranch_scc1 FB_P1
    v_mov_b32 v116, v68
    s_nop 1
    v_permlane32_swap_b32 v116, v68
    s_nop 1
    v_max_f32 v68, v116, v68
    v_mov_b32 v116, v68
    s_nop 1
    v_permlane16_swap_b32 v116, v68
    s_nop 1
    v_max_f32 v68, v116, v68
    v_mov_b32 v116, v69
    s_nop 1
    v_permlane32_swap_b32 v116, v69
    s_nop 1
    v_max_f32 v69, v116, v69
    v_mov_b32 v116, v69
    s_nop 1
    v_permlane16_swap_b32 v116, v69
    s_nop 1
    v_max_f32 v69, v116, v69
    v_mov_b32 v116, v70
    s_nop 1
    v_permlane32_swap_b32 v116, v70
    s_nop 1
    v_max_f32 v70, v116, v70
    v_mov_b32 v116, v70
    s_nop 1
    v_permlane16_swap_b32 v116, v70
    s_nop 1
    v_max_f32 v70, v116, v70
    v_mov_b32 v116, v71
    s_nop 1
    v_permlane32_swap_b32 v116, v71
    s_nop 1
    v_max_f32 v71, v116, v71
    v_mov_b32 v116, v71
    s_nop 1
    v_permlane16_swap_b32 v116, v71
    s_nop 1
    v_max_f32 v71, v116, v71
    v_mov_b32 v128, 0
    v_mov_b32 v129, 0
    v_mov_b32 v130, 0
    v_mov_b32 v131, 0
    v_mov_b32 v132, 0
    v_mov_b32 v133, 0
    v_mov_b32 v134, 0
    v_mov_b32 v135, 0
    v_mov_b32 v136, 0
    v_mov_b32 v137, 0
    v_mov_b32 v138, 0
    v_mov_b32 v139, 0
    v_mov_b32 v140, 0
    v_mov_b32 v141, 0
    v_mov_b32 v142, 0
    v_mov_b32 v143, 0
    v_mov_b32 v144, 0
    v_mov_b32 v145, 0
    v_mov_b32 v146, 0
    v_mov_b32 v147, 0
    v_mov_b32 v148, 0
    v_mov_b32 v149, 0
    v_mov_b32 v150, 0
    v_mov_b32 v151, 0
    v_mov_b32 v152, 0
    v_mov_b32 v153, 0
    v_mov_b32 v154, 0
    v_mov_b32 v155, 0
    v_mov_b32 v156, 0
    v_mov_b32 v157, 0
    v_mov_b32 v158, 0
    v_mov_b32 v159, 0
    v_mov_b32 v160, 0
    v_mov_b32 v161, 0
    v_mov_b32 v162, 0
    v_mov_b32 v163, 0
    v_mov_b32 v164, 0
    v_mov_b32 v165, 0
    v_mov_b32 v166, 0
    v_mov_b32 v167, 0
    v_mov_b32 v168, 0
    v_mov_b32 v169, 0
    v_mov_b32 v170, 0
    v_mov_b32 v171, 0
    v_mov_b32 v172, 0
    v_mov_b32 v173, 0
    v_mov_b32 v174, 0
    v_mov_b32 v175, 0
    v_mov_b32 v176, 0
    v_mov_b32 v177, 0
    v_mov_b32 v178, 0
    v_mov_b32 v179, 0
    v_mov_b32 v180, 0
    v_mov_b32 v181, 0
    v_mov_b32 v182, 0
    v_mov_b32 v183, 0
    v_mov_b32 v184, 0
    v_mov_b32 v185, 0
    v_mov_b32 v186, 0
    v_mov_b32 v187, 0
    v_mov_b32 v188, 0
    v_mov_b32 v189, 0
    v_mov_b32 v190, 0
    v_mov_b32 v191, 0
    v_mov_b32 v192, 0
    v_mov_b32 v193, 0
    v_mov_b32 v194, 0
    v_mov_b32 v195, 0
    v_mov_b32 v196, 0
    v_mov_b32 v197, 0
    v_mov_b32 v198, 0
    v_mov_b32 v199, 0
    v_mov_b32 v200, 0
    v_mov_b32 v201, 0
    v_mov_b32 v202, 0
    v_mov_b32 v203, 0
    v_mov_b32 v204, 0
    v_mov_b32 v205, 0
    v_mov_b32 v206, 0
    v_mov_b32 v207, 0
    v_mov_b32 v208, 0
    v_mov_b32 v209, 0
    v_mov_b32 v210, 0
    v_mov_b32 v211, 0
    v_mov_b32 v212, 0
    v_mov_b32 v213, 0
    v_mov_b32 v214, 0
    v_mov_b32 v215, 0
    v_mov_b32 v216, 0
    v_mov_b32 v217, 0
    v_mov_b32 v218, 0
    v_mov_b32 v219, 0
    v_mov_b32 v220, 0
    v_mov_b32 v221, 0
    v_mov_b32 v222, 0
    v_mov_b32 v223, 0
    v_mov_b32 v224, 0
    v_mov_b32 v225, 0
    v_mov_b32 v226, 0
    v_mov_b32 v227, 0
    v_mov_b32 v228, 0
    v_mov_b32 v229, 0
    v_mov_b32 v230, 0
    v_mov_b32 v231, 0
    v_mov_b32 v232, 0
    v_mov_b32 v233, 0
    v_mov_b32 v234, 0
    v_mov_b32 v235, 0
    v_mov_b32 v236, 0
    v_mov_b32 v237, 0
    v_mov_b32 v238, 0
    v_mov_b32 v239, 0
    v_mov_b32 v240, 0
    v_mov_b32 v241, 0
    v_mov_b32 v242, 0
    v_mov_b32 v243, 0
    v_mov_b32 v244, 0
    v_mov_b32 v245, 0
    v_mov_b32 v246, 0
    v_mov_b32 v247, 0
    v_mov_b32 v248, 0
    v_mov_b32 v249, 0
    v_mov_b32 v250, 0
    v_mov_b32 v251, 0
    v_mov_b32 v252, 0
    v_mov_b32 v253, 0
    v_mov_b32 v254, 0
    v_mov_b32 v255, 0
    v_mov_b32 v52, 0
    v_mov_b32 v53, 0
    v_mov_b32 v54, 0
    v_mov_b32 v55, 0
    v_mov_b32 v56, 0
    v_mov_b32 v57, 0
    v_mov_b32 v58, 0
    v_mov_b32 v59, 0
    v_mov_b32 v60, 0
    v_mov_b32 v61, 0
    v_mov_b32 v62, 0
    v_mov_b32 v63, 0
    v_mov_b32 v64, 0
    v_mov_b32 v65, 0
    v_mov_b32 v66, 0
    v_mov_b32 v67, 0
    s_sub_u32 s29, s29, 262144
FB_P2:
    s_add_u32 m0, s47, 0
    s_add_u32 s44, s29, 0
    buffer_load_dwordx4 v10, s[16:19], s44 offen offset:0 lds
    buffer_load_dwordx4 v11, s[16:19], s44 offen offset:1024 lds
    buffer_load_dwordx4 v12, s[16:19], s44 offen offset:2048 lds
    buffer_load_dwordx4 v13, s[16:19], s44 offen offset:3072 lds
    s_add_u32 m0, s47, 4096
    s_add_u32 s44, s29, 4096
    buffer_load_dwordx4 v10, s[16:19], s44 offen offset:0 lds
    buffer_load_dwordx4 v11, s[16:19], s44 offen offset:1024 lds
    buffer_load_dwordx4 v12, s[16:19], s44 offen offset:2048 lds
    buffer_load_dwordx4 v13, s[16:19], s44 offen offset:3072 lds
    s_add_u32 m0, s47, 8192
    s_add_u32 s44, s29, 8192
    buffer_load_dwordx4 v10, s[16:19], s44 offen offset:0 lds
    buffer_load_dwordx4 v11, s[16:19], s44 offen offset:1024 lds
    buffer_load_dwordx4 v12, s[16:19], s44 offen offset:2048 lds
    buffer_load_dwordx4 v13, s[16:19], s44 offen offset:3072 lds
    s_add_u32 m0, s47, 12288
    s_add_u32 s44, s29, 12288
    buffer_load_dwordx4 v10, s[16:19], s44 offen offset:0 lds
    buffer_load_dwordx4 v11, s[16:19], s44 offen offset:1024 lds
    buffer_load_dwordx4 v12, s[16:19], s44 offen offset:2048 lds
    buffer_load_dwordx4 v13, s[16:19], s44 offen offset:3072 lds
    s_waitcnt vmcnt(0)
    ds_read_b128 a[64:67], v5 offset:0
    ds_read_b128 a[68:71], v5 offset:256
    ds_read_b128 a[72:75], v5 offset:512
    ds_read_b128 a[76:79], v5 offset:768
    ds_read_b128 a[80:83], v5 offset:4096
    ds_read_b128 a[84:87], v5 offset:4352
    ds_read_b128 a[88:91], v5 offset:4608
    ds_read_b128 a[92:95], v5 offset:4864
    s_waitcnt lgkmcnt(0)
    ds_read_b128 a[96:99], v5 offset:8192
    ds_read_b128 a[100:103], v5 offset:8448
    ds_read_b128 a[104:107], v5 offset:8704
    ds_read_b128 a[108:111], v5 offset:8960
    ds_read_b128 a[112:115], v5 offset:12288
    ds_read_b128 a[116:119], v5 offset:12544
    ds_read_b128 a[120:123], v5 offset:12800
    ds_read_b128 a[124:127], v5 offset:13056
    s_waitcnt lgkmcnt(0)
    s_add_u32 m0, s47, 0
    s_add_u32 s44, s29, 0
    buffer_load_dwordx4 v10, s[20:23], s44 offen offset:0 lds
    buffer_load_dwordx4 v11, s[20:23], s44 offen offset:1024 lds
    buffer_load_dwordx4 v12, s[20:23], s44 offen offset:2048 lds
    buffer_load_dwordx4 v13, s[20:23], s44 offen offset:3072 lds
    s_add_u32 m0, s47, 4096
    s_add_u32 s44, s29, 4096
    buffer_load_dwordx4 v10, s[20:23], s44 offen offset:0 lds
    buffer_load_dwordx4 v11, s[20:23], s44 offen offset:1024 lds
    buffer_load_dwordx4 v12, s[20:23], s44 offen offset:2048 lds
    buffer_load_dwordx4 v13, s[20:23], s44 offen offset:3072 lds
    s_add_u32 m0, s47, 8192
    s_add_u32 s44, s29, 8192
    buffer_load_dwordx4 v10, s[20:23], s44 offen offset:0 lds
    buffer_load_dwordx4 v11, s[20:23], s44 offen offset:1024 lds
    buffer_load_dwordx4 v12, s[20:23], s44 offen offset:2048 lds
    buffer_load_dwordx4 v13, s[20:23], s44 offen offset:3072 lds
    s_add_u32 m0, s47, 12288
    s_add_u32 s44, s29, 12288
    buffer_load_dwordx4 v10, s[20:23], s44 offen offset:0 lds
    buffer_load_dwordx4 v11, s[20:23], s44 offen offset:1024 lds
    buffer_load_dwordx4 v12, s[20:23], s44 offen offset:2048 lds
    buffer_load_dwordx4 v13, s[20:23], s44 offen offset:3072 lds
    s_waitcnt vmcnt(0)
    ds_read_b64_tr_b16 a[128:129], v3 offset:0
    ds_read_b64_tr_b16 a[130:131], v3 offset:4096
    ds_read_b64_tr_b16 a[132:133], v3 offset:8192
    ds_read_b64_tr_b16 a[134:135], v3 offset:12288
    ds_read_b64_tr_b16 a[136:137], v4 offset:0
    ds_read_b64_tr_b16 a[138:139], v4 offset:4096
    ds_read_b64_tr_b16 a[140:141], v4 offset:8192
    ds_read_b64_tr_b16 a[142:143], v4 offset:12288
    s_waitcnt lgkmcnt(0)
    ds_read_b64_tr_b16 a[144:145], v3 offset:256
    ds_read_b64_tr_b16 a[146:147], v3 offset:4352
    ds_read_b64_tr_b16 a[148:149], v3 offset:8448
    ds_read_b64_tr_b16 a[150:151], v3 offset:12544
    ds_read_b64_tr_b16 a[152:153], v4 offset:256
    ds_read_b64_tr_b16 a[154:155], v4 offset:4352
    ds_read_b64_tr_b16 a[156:157], v4 offset:8448
    ds_read_b64_tr_b16 a[158:159], v4 offset:12544
    s_waitcnt lgkmcnt(0)
    ds_read_b64_tr_b16 a[160:161], v3 offset:512
    ds_read_b64_tr_b16 a[162:163], v3 offset:4608
    ds_read_b64_tr_b16 a[164:165], v3 offset:8704
    ds_read_b64_tr_b16 a[166:167], v3 offset:12800
    ds_read_b64_tr_b16 a[168:169], v4 offset:512
    ds_read_b64_tr_b16 a[170:171], v4 offset:4608
    ds_read_b64_tr_b16 a[172:173], v4 offset:8704
    ds_read_b64_tr_b16 a[174:175], v4 offset:12800
    s_waitcnt lgkmcnt(0)
    ds_read_b64_tr_b16 a[176:177], v3 offset:768
    ds_read_b64_tr_b16 a[178:179], v3 offset:4864
    ds_read_b64_tr_b16 a[180:181], v3 offset:8960
    ds_read_b64_tr_b16 a[182:183], v3 offset:13056
    ds_read_b64_tr_b16 a[184:185], v4 offset:768
    ds_read_b64_tr_b16 a[186:187], v4 offset:4864
    ds_read_b64_tr_b16 a[188:189], v4 offset:8960
    ds_read_b64_tr_b16 a[190:191], v4 offset:13056
    s_waitcnt lgkmcnt(0)
    v_mfma_f32_16x16x32_bf16 v[20:23], a[64:67], a[0:3], 0
    v_mfma_f32_16x16x32_bf16 v[20:23], a[68:71], a[4:7], v[20:23]
    v_mfma_f32_16x16x32_bf16 v[20:23], a[72:75], a[8:11], v[20:23]
    v_mfma_f32_16x16x32_bf16 v[20:23], a[76:79], a[12:15], v[20:23]
    v_mfma_f32_16x16x32_bf16 v[24:27], a[80:83], a[0:3], 0
    v_mfma_f32_16x16x32_bf16 v[24:27], a[84:87], a[4:7], v[24:27]
    v_mfma_f32_16x16x32_bf16 v[24:27], a[88:91], a[8:11], v[24:27]
    v_mfma_f32_16x16x32_bf16 v[24:27], a[92:95], a[12:15], v[24:27]
    v_mfma_f32_16x16x32_bf16 v[28:31], a[96:99], a[0:3], 0
    v_mfma_f32_16x16x32_bf16 v[28:31], a[100:103], a[4:7], v[28:31]
    v_mfma_f32_16x16x32_bf16 v[28:31], a[104:107], a[8:11], v[28:31]
    v_mfma_f32_16x16x32_bf16 v[28:31], a[108:111], a[12:15], v[28:31]
    v_mfma_f32_16x16x32_bf16 v[32:35], a[112:115], a[0:3], 0
    v_mfma_f32_16x16x32_bf16 v[32:35], a[116:119], a[4:7], v[32:35]
    v_mfma_f32_16x16x32_bf16 v[32:35], a[120:123], a[8:11], v[32:35]
    v_mfma_f32_16x16x32_bf16 v[32:35], a[124:127], a[12:15], v[32:35]
    s_nop 7
    v_sub_f32 v20, v20, v68
    v_mul_f32 v20, s28, v20
    v_exp_f32 v20, v20
    v_sub_f32 v21, v21, v68
    v_mul_f32 v21, s28, v21
    v_exp_f32 v21, v21
    v_sub_f32 v22, v22, v68
    v_mul_f32 v22, s28, v22
    v_exp_f32 v22, v22
    v_sub_f32 v23, v23, v68
    v_mul_f32 v23, s28, v23
    v_exp_f32 v23, v23
    v_sub_f32 v24, v24, v68
    v_mul_f32 v24, s28, v24
    v_exp_f32 v24, v24
    v_sub_f32 v25, v25, v68
    v_mul_f32 v25, s28, v25
    v_exp_f32 v25, v25
    v_sub_f32 v26, v26, v68
    v_mul_f32 v26, s28, v26
    v_exp_f32 v26, v26
    v_sub_f32 v27, v27, v68
    v_mul_f32 v27, s28, v27
    v_exp_f32 v27, v27
    v_sub_f32 v28, v28, v68
    v_mul_f32 v28, s28, v28
    v_exp_f32 v28, v28
    v_sub_f32 v29, v29, v68
    v_mul_f32 v29, s28, v29
    v_exp_f32 v29, v29
    v_sub_f32 v30, v30, v68
    v_mul_f32 v30, s28, v30
    v_exp_f32 v30, v30
    v_sub_f32 v31, v31, v68
    v_mul_f32 v31, s28, v31
    v_exp_f32 v31, v31
    v_sub_f32 v32, v32, v68
    v_mul_f32 v32, s28, v32
    v_exp_f32 v32, v32
    v_sub_f32 v33, v33, v68
    v_mul_f32 v33, s28, v33
    v_exp_f32 v33, v33
    v_sub_f32 v34, v34, v68
    v_mul_f32 v34, s28, v34
    v_exp_f32 v34, v34
    v_sub_f32 v35, v35, v68
    v_mul_f32 v35, s28, v35
    v_exp_f32 v35, v35
    s_nop 0
    v_cvt_pk_bf16_f32 v36, v20, v21
    v_cvt_pk_bf16_f32 v37, v22, v23
    v_cvt_pk_bf16_f32 v38, v24, v25
    v_cvt_pk_bf16_f32 v39, v26, v27
    v_cvt_pk_bf16_f32 v40, v28, v29
    v_cvt_pk_bf16_f32 v41, v30, v31
    v_cvt_pk_bf16_f32 v42, v32, v33
    v_cvt_pk_bf16_f32 v43, v34, v35
    s_nop 1
    v_mfma_f32_16x16x32_bf16 v[128:131], a[128:131], v[36:39], v[128:131]
    v_mfma_f32_16x16x32_bf16 v[128:131], a[132:135], v[40:43], v[128:131]
    v_mfma_f32_16x16x32_bf16 v[132:135], a[136:139], v[36:39], v[132:135]
    v_mfma_f32_16x16x32_bf16 v[132:135], a[140:143], v[40:43], v[132:135]
    v_mfma_f32_16x16x32_bf16 v[136:139], a[144:147], v[36:39], v[136:139]
    v_mfma_f32_16x16x32_bf16 v[136:139], a[148:151], v[40:43], v[136:139]
    v_mfma_f32_16x16x32_bf16 v[140:143], a[152:155], v[36:39], v[140:143]
    v_mfma_f32_16x16x32_bf16 v[140:143], a[156:159], v[40:43], v[140:143]
    v_mfma_f32_16x16x32_bf16 v[144:147], a[160:163], v[36:39], v[144:147]
    v_mfma_f32_16x16x32_bf16 v[144:147], a[164:167], v[40:43], v[144:147]
    v_mfma_f32_16x16x32_bf16 v[148:151], a[168:171], v[36:39], v[148:151]
    v_mfma_f32_16x16x32_bf16 v[148:151], a[172:175], v[40:43], v[148:151]
    v_mfma_f32_16x16x32_bf16 v[152:155], a[176:179], v[36:39], v[152:155]
    v_mfma_f32_16x16x32_bf16 v[152:155], a[180:183], v[40:43], v[152:155]
    v_mfma_f32_16x16x32_bf16 v[156:159], a[184:187], v[36:39], v[156:159]
    v_mfma_f32_16x16x32_bf16 v[156:159], a[188:191], v[40:43], v[156:159]
    v_smfmac_f32_16x16x64_bf16 v[52:55], v[16:19], v[36:43], v14
    v_mfma_f32_16x16x32_bf16 v[20:23], a[64:67], a[16:19], 0
    v_mfma_f32_16x16x32_bf16 v[20:23], a[68:71], a[20:23], v[20:23]
    v_mfma_f32_16x16x32_bf16 v[20:23], a[72:75], a[24:27], v[20:23]
    v_mfma_f32_16x16x32_bf16 v[20:23], a[76:79], a[28:31], v[20:23]
    v_mfma_f32_16x16x32_bf16 v[24:27], a[80:83], a[16:19], 0
    v_mfma_f32_16x16x32_bf16 v[24:27], a[84:87], a[20:23], v[24:27]
    v_mfma_f32_16x16x32_bf16 v[24:27], a[88:91], a[24:27], v[24:27]
    v_mfma_f32_16x16x32_bf16 v[24:27], a[92:95], a[28:31], v[24:27]
    v_mfma_f32_16x16x32_bf16 v[28:31], a[96:99], a[16:19], 0
    v_mfma_f32_16x16x32_bf16 v[28:31], a[100:103], a[20:23], v[28:31]
    v_mfma_f32_16x16x32_bf16 v[28:31], a[104:107], a[24:27], v[28:31]
    v_mfma_f32_16x16x32_bf16 v[28:31], a[108:111], a[28:31], v[28:31]
    v_mfma_f32_16x16x32_bf16 v[32:35], a[112:115], a[16:19], 0
    v_mfma_f32_16x16x32_bf16 v[32:35], a[116:119], a[20:23], v[32:35]
    v_mfma_f32_16x16x32_bf16 v[32:35], a[120:123], a[24:27], v[32:35]
    v_mfma_f32_16x16x32_bf16 v[32:35], a[124:127], a[28:31], v[32:35]
    s_nop 7
    v_sub_f32 v20, v20, v69
    v_mul_f32 v20, s28, v20
    v_exp_f32 v20, v20
    v_sub_f32 v21, v21, v69
    v_mul_f32 v21, s28, v21
    v_exp_f32 v21, v21
    v_sub_f32 v22, v22, v69
    v_mul_f32 v22, s28, v22
    v_exp_f32 v22, v22
    v_sub_f32 v23, v23, v69
    v_mul_f32 v23, s28, v23
    v_exp_f32 v23, v23
    v_sub_f32 v24, v24, v69
    v_mul_f32 v24, s28, v24
    v_exp_f32 v24, v24
    v_sub_f32 v25, v25, v69
    v_mul_f32 v25, s28, v25
    v_exp_f32 v25, v25
    v_sub_f32 v26, v26, v69
    v_mul_f32 v26, s28, v26
    v_exp_f32 v26, v26
    v_sub_f32 v27, v27, v69
    v_mul_f32 v27, s28, v27
    v_exp_f32 v27, v27
    v_sub_f32 v28, v28, v69
    v_mul_f32 v28, s28, v28
    v_exp_f32 v28, v28
    v_sub_f32 v29, v29, v69
    v_mul_f32 v29, s28, v29
    v_exp_f32 v29, v29
    v_sub_f32 v30, v30, v69
    v_mul_f32 v30, s28, v30
    v_exp_f32 v30, v30
    v_sub_f32 v31, v31, v69
    v_mul_f32 v31, s28, v31
    v_exp_f32 v31, v31
    v_sub_f32 v32, v32, v69
    v_mul_f32 v32, s28, v32
    v_exp_f32 v32, v32
    v_sub_f32 v33, v33, v69
    v_mul_f32 v33, s28, v33
    v_exp_f32 v33, v33
    v_sub_f32 v34, v34, v69
    v_mul_f32 v34, s28, v34
    v_exp_f32 v34, v34
    v_sub_f32 v35, v35, v69
    v_mul_f32 v35, s28, v35
    v_exp_f32 v35, v35
    s_nop 0
    v_cvt_pk_bf16_f32 v36, v20, v21
    v_cvt_pk_bf16_f32 v37, v22, v23
    v_cvt_pk_bf16_f32 v38, v24, v25
    v_cvt_pk_bf16_f32 v39, v26, v27
    v_cvt_pk_bf16_f32 v40, v28, v29
    v_cvt_pk_bf16_f32 v41, v30, v31
    v_cvt_pk_bf16_f32 v42, v32, v33
    v_cvt_pk_bf16_f32 v43, v34, v35
    s_nop 1
    v_mfma_f32_16x16x32_bf16 v[160:163], a[128:131], v[36:39], v[160:163]
    v_mfma_f32_16x16x32_bf16 v[160:163], a[132:135], v[40:43], v[160:163]
    v_mfma_f32_16x16x32_bf16 v[164:167], a[136:139], v[36:39], v[164:167]
    v_mfma_f32_16x16x32_bf16 v[164:167], a[140:143], v[40:43], v[164:167]
    v_mfma_f32_16x16x32_bf16 v[168:171], a[144:147], v[36:39], v[168:171]
    v_mfma_f32_16x16x32_bf16 v[168:171], a[148:151], v[40:43], v[168:171]
    v_mfma_f32_16x16x32_bf16 v[172:175], a[152:155], v[36:39], v[172:175]
    v_mfma_f32_16x16x32_bf16 v[172:175], a[156:159], v[40:43], v[172:175]
    v_mfma_f32_16x16x32_bf16 v[176:179], a[160:163], v[36:39], v[176:179]
    v_mfma_f32_16x16x32_bf16 v[176:179], a[164:167], v[40:43], v[176:179]
    v_mfma_f32_16x16x32_bf16 v[180:183], a[168:171], v[36:39], v[180:183]
    v_mfma_f32_16x16x32_bf16 v[180:183], a[172:175], v[40:43], v[180:183]
    v_mfma_f32_16x16x32_bf16 v[184:187], a[176:179], v[36:39], v[184:187]
    v_mfma_f32_16x16x32_bf16 v[184:187], a[180:183], v[40:43], v[184:187]
    v_mfma_f32_16x16x32_bf16 v[188:191], a[184:187], v[36:39], v[188:191]
    v_mfma_f32_16x16x32_bf16 v[188:191], a[188:191], v[40:43], v[188:191]
    v_smfmac_f32_16x16x64_bf16 v[56:59], v[16:19], v[36:43], v14
    v_mfma_f32_16x16x32_bf16 v[20:23], a[64:67], a[32:35], 0
    v_mfma_f32_16x16x32_bf16 v[20:23], a[68:71], a[36:39], v[20:23]
    v_mfma_f32_16x16x32_bf16 v[20:23], a[72:75], a[40:43], v[20:23]
    v_mfma_f32_16x16x32_bf16 v[20:23], a[76:79], a[44:47], v[20:23]
    v_mfma_f32_16x16x32_bf16 v[24:27], a[80:83], a[32:35], 0
    v_mfma_f32_16x16x32_bf16 v[24:27], a[84:87], a[36:39], v[24:27]
    v_mfma_f32_16x16x32_bf16 v[24:27], a[88:91], a[40:43], v[24:27]
    v_mfma_f32_16x16x32_bf16 v[24:27], a[92:95], a[44:47], v[24:27]
    v_mfma_f32_16x16x32_bf16 v[28:31], a[96:99], a[32:35], 0
    v_mfma_f32_16x16x32_bf16 v[28:31], a[100:103], a[36:39], v[28:31]
    v_mfma_f32_16x16x32_bf16 v[28:31], a[104:107], a[40:43], v[28:31]
    v_mfma_f32_16x16x32_bf16 v[28:31], a[108:111], a[44:47], v[28:31]
    v_mfma_f32_16x16x32_bf16 v[32:35], a[112:115], a[32:35], 0
    v_mfma_f32_16x16x32_bf16 v[32:35], a[116:119], a[36:39], v[32:35]
    v_mfma_f32_16x16x32_bf16 v[32:35], a[120:123], a[40:43], v[32:35]
    v_mfma_f32_16x16x32_bf16 v[32:35], a[124:127], a[44:47], v[32:35]
    s_nop 7
    v_sub_f32 v20, v20, v70
    v_mul_f32 v20, s28, v20
    v_exp_f32 v20, v20
    v_sub_f32 v21, v21, v70
    v_mul_f32 v21, s28, v21
    v_exp_f32 v21, v21
    v_sub_f32 v22, v22, v70
    v_mul_f32 v22, s28, v22
    v_exp_f32 v22, v22
    v_sub_f32 v23, v23, v70
    v_mul_f32 v23, s28, v23
    v_exp_f32 v23, v23
    v_sub_f32 v24, v24, v70
    v_mul_f32 v24, s28, v24
    v_exp_f32 v24, v24
    v_sub_f32 v25, v25, v70
    v_mul_f32 v25, s28, v25
    v_exp_f32 v25, v25
    v_sub_f32 v26, v26, v70
    v_mul_f32 v26, s28, v26
    v_exp_f32 v26, v26
    v_sub_f32 v27, v27, v70
    v_mul_f32 v27, s28, v27
    v_exp_f32 v27, v27
    v_sub_f32 v28, v28, v70
    v_mul_f32 v28, s28, v28
    v_exp_f32 v28, v28
    v_sub_f32 v29, v29, v70
    v_mul_f32 v29, s28, v29
    v_exp_f32 v29, v29
    v_sub_f32 v30, v30, v70
    v_mul_f32 v30, s28, v30
    v_exp_f32 v30, v30
    v_sub_f32 v31, v31, v70
    v_mul_f32 v31, s28, v31
    v_exp_f32 v31, v31
    v_sub_f32 v32, v32, v70
    v_mul_f32 v32, s28, v32
    v_exp_f32 v32, v32
    v_sub_f32 v33, v33, v70
    v_mul_f32 v33, s28, v33
    v_exp_f32 v33, v33
    v_sub_f32 v34, v34, v70
    v_mul_f32 v34, s28, v34
    v_exp_f32 v34, v34
    v_sub_f32 v35, v35, v70
    v_mul_f32 v35, s28, v35
    v_exp_f32 v35, v35
    s_nop 0
    v_cvt_pk_bf16_f32 v36, v20, v21
    v_cvt_pk_bf16_f32 v37, v22, v23
    v_cvt_pk_bf16_f32 v38, v24, v25
    v_cvt_pk_bf16_f32 v39, v26, v27
    v_cvt_pk_bf16_f32 v40, v28, v29
    v_cvt_pk_bf16_f32 v41, v30, v31
    v_cvt_pk_bf16_f32 v42, v32, v33
    v_cvt_pk_bf16_f32 v43, v34, v35
    s_nop 1
    v_mfma_f32_16x16x32_bf16 v[192:195], a[128:131], v[36:39], v[192:195]
    v_mfma_f32_16x16x32_bf16 v[192:195], a[132:135], v[40:43], v[192:195]
    v_mfma_f32_16x16x32_bf16 v[196:199], a[136:139], v[36:39], v[196:199]
    v_mfma_f32_16x16x32_bf16 v[196:199], a[140:143], v[40:43], v[196:199]
    v_mfma_f32_16x16x32_bf16 v[200:203], a[144:147], v[36:39], v[200:203]
    v_mfma_f32_16x16x32_bf16 v[200:203], a[148:151], v[40:43], v[200:203]
    v_mfma_f32_16x16x32_bf16 v[204:207], a[152:155], v[36:39], v[204:207]
    v_mfma_f32_16x16x32_bf16 v[204:207], a[156:159], v[40:43], v[204:207]
    v_mfma_f32_16x16x32_bf16 v[208:211], a[160:163], v[36:39], v[208:211]
    v_mfma_f32_16x16x32_bf16 v[208:211], a[164:167], v[40:43], v[208:211]
    v_mfma_f32_16x16x32_bf16 v[212:215], a[168:171], v[36:39], v[212:215]
    v_mfma_f32_16x16x32_bf16 v[212:215], a[172:175], v[40:43], v[212:215]
    v_mfma_f32_16x16x32_bf16 v[216:219], a[176:179], v[36:39], v[216:219]
    v_mfma_f32_16x16x32_bf16 v[216:219], a[180:183], v[40:43], v[216:219]
    v_mfma_f32_16x16x32_bf16 v[220:223], a[184:187], v[36:39], v[220:223]
    v_mfma_f32_16x16x32_bf16 v[220:223], a[188:191], v[40:43], v[220:223]
    v_smfmac_f32_16x16x64_bf16 v[60:63], v[16:19], v[36:43], v14
    v_mfma_f32_16x16x32_bf16 v[20:23], a[64:67], a[48:51], 0
    v_mfma_f32_16x16x32_bf16 v[20:23], a[68:71], a[52:55], v[20:23]
    v_mfma_f32_16x16x32_bf16 v[20:23], a[72:75], a[56:59], v[20:23]
    v_mfma_f32_16x16x32_bf16 v[20:23], a[76:79], a[60:63], v[20:23]
    v_mfma_f32_16x16x32_bf16 v[24:27], a[80:83], a[48:51], 0
    v_mfma_f32_16x16x32_bf16 v[24:27], a[84:87], a[52:55], v[24:27]
    v_mfma_f32_16x16x32_bf16 v[24:27], a[88:91], a[56:59], v[24:27]
    v_mfma_f32_16x16x32_bf16 v[24:27], a[92:95], a[60:63], v[24:27]
    v_mfma_f32_16x16x32_bf16 v[28:31], a[96:99], a[48:51], 0
    v_mfma_f32_16x16x32_bf16 v[28:31], a[100:103], a[52:55], v[28:31]
    v_mfma_f32_16x16x32_bf16 v[28:31], a[104:107], a[56:59], v[28:31]
    v_mfma_f32_16x16x32_bf16 v[28:31], a[108:111], a[60:63], v[28:31]
    v_mfma_f32_16x16x32_bf16 v[32:35], a[112:115], a[48:51], 0
    v_mfma_f32_16x16x32_bf16 v[32:35], a[116:119], a[52:55], v[32:35]
    v_mfma_f32_16x16x32_bf16 v[32:35], a[120:123], a[56:59], v[32:35]
    v_mfma_f32_16x16x32_bf16 v[32:35], a[124:127], a[60:63], v[32:35]
    s_nop 7
    v_sub_f32 v20, v20, v71
    v_mul_f32 v20, s28, v20
    v_exp_f32 v20, v20
    v_sub_f32 v21, v21, v71
    v_mul_f32 v21, s28, v21
    v_exp_f32 v21, v21
    v_sub_f32 v22, v22, v71
    v_mul_f32 v22, s28, v22
    v_exp_f32 v22, v22
    v_sub_f32 v23, v23, v71
    v_mul_f32 v23, s28, v23
    v_exp_f32 v23, v23
    v_sub_f32 v24, v24, v71
    v_mul_f32 v24, s28, v24
    v_exp_f32 v24, v24
    v_sub_f32 v25, v25, v71
    v_mul_f32 v25, s28, v25
    v_exp_f32 v25, v25
    v_sub_f32 v26, v26, v71
    v_mul_f32 v26, s28, v26
    v_exp_f32 v26, v26
    v_sub_f32 v27, v27, v71
    v_mul_f32 v27, s28, v27
    v_exp_f32 v27, v27
    v_sub_f32 v28, v28, v71
    v_mul_f32 v28, s28, v28
    v_exp_f32 v28, v28
    v_sub_f32 v29, v29, v71
    v_mul_f32 v29, s28, v29
    v_exp_f32 v29, v29
    v_sub_f32 v30, v30, v71
    v_mul_f32 v30, s28, v30
    v_exp_f32 v30, v30
    v_sub_f32 v31, v31, v71
    v_mul_f32 v31, s28, v31
    v_exp_f32 v31, v31
    v_sub_f32 v32, v32, v71
    v_mul_f32 v32, s28, v32
    v_exp_f32 v32, v32
    v_sub_f32 v33, v33, v71
    v_mul_f32 v33, s28, v33
    v_exp_f32 v33, v33
    v_sub_f32 v34, v34, v71
    v_mul_f32 v34, s28, v34
    v_exp_f32 v34, v34
    v_sub_f32 v35, v35, v71
    v_mul_f32 v35, s28, v35
    v_exp_f32 v35, v35
    s_nop 0
    v_cvt_pk_bf16_f32 v36, v20, v21
    v_cvt_pk_bf16_f32 v37, v22, v23
    v_cvt_pk_bf16_f32 v38, v24, v25
    v_cvt_pk_bf16_f32 v39, v26, v27
    v_cvt_pk_bf16_f32 v40, v28, v29
    v_cvt_pk_bf16_f32 v41, v30, v31
    v_cvt_pk_bf16_f32 v42, v32, v33
    v_cvt_pk_bf16_f32 v43, v34, v35
    s_nop 1
    v_mfma_f32_16x16x32_bf16 v[224:227], a[128:131], v[36:39], v[224:227]
    v_mfma_f32_16x16x32_bf16 v[224:227], a[132:135], v[40:43], v[224:227]
    v_mfma_f32_16x16x32_bf16 v[228:231], a[136:139], v[36:39], v[228:231]
    v_mfma_f32_16x16x32_bf16 v[228:231], a[140:143], v[40:43], v[228:231]
    v_mfma_f32_16x16x32_bf16 v[232:235], a[144:147], v[36:39], v[232:235]
    v_mfma_f32_16x16x32_bf16 v[232:235], a[148:151], v[40:43], v[232:235]
    v_mfma_f32_16x16x32_bf16 v[236:239], a[152:155], v[36:39], v[236:239]
    v_mfma_f32_16x16x32_bf16 v[236:239], a[156:159], v[40:43], v[236:239]
    v_mfma_f32_16x16x32_bf16 v[240:243], a[160:163], v[36:39], v[240:243]
    v_mfma_f32_16x16x32_bf16 v[240:243], a[164:167], v[40:43], v[240:243]
    v_mfma_f32_16x16x32_bf16 v[244:247], a[168:171], v[36:39], v[244:247]
    v_mfma_f32_16x16x32_bf16 v[244:247], a[172:175], v[40:43], v[244:247]
    v_mfma_f32_16x16x32_bf16 v[248:251], a[176:179], v[36:39], v[248:251]
    v_mfma_f32_16x16x32_bf16 v[248:251], a[180:183], v[40:43], v[248:251]
    v_mfma_f32_16x16x32_bf16 v[252:255], a[184:187], v[36:39], v[252:255]
    v_mfma_f32_16x16x32_bf16 v[252:255], a[188:191], v[40:43], v[252:255]
    v_smfmac_f32_16x16x64_bf16 v[64:67], v[16:19], v[36:43], v14
    s_add_u32 s29, s29, 16384
    s_cmp_lt_u32 s29, s33
    s_cbranch_scc1 FB_P2
    s_nop 7
    v_add_f32 v120, v52, v53
    v_rcp_f32 v122, v120
    s_nop 0
    v_mul_f32 v128, v122, v128
    v_mul_f32 v129, v122, v129
    v_mul_f32 v130, v122, v130
    v_mul_f32 v131, v122, v131
    v_cvt_pk_bf16_f32 v84, v128, v129
    v_cvt_pk_bf16_f32 v85, v130, v131
    v_mul_f32 v144, v122, v144
    v_mul_f32 v145, v122, v145
    v_mul_f32 v146, v122, v146
    v_mul_f32 v147, v122, v147
    v_cvt_pk_bf16_f32 v92, v144, v145
    v_cvt_pk_bf16_f32 v93, v146, v147
    ds_write2st64_b64 v76, v[84:85], v[92:93] offset0:0 offset1:16
    v_mul_f32 v132, v122, v132
    v_mul_f32 v133, v122, v133
    v_mul_f32 v134, v122, v134
    v_mul_f32 v135, v122, v135
    v_cvt_pk_bf16_f32 v86, v132, v133
    v_cvt_pk_bf16_f32 v87, v134, v135
    v_mul_f32 v148, v122, v148
    v_mul_f32 v149, v122, v149
    v_mul_f32 v150, v122, v150
    v_mul_f32 v151, v122, v151
    v_cvt_pk_bf16_f32 v94, v148, v149
    v_cvt_pk_bf16_f32 v95, v150, v151
    ds_write2st64_b64 v77, v[86:87], v[94:95] offset0:0 offset1:16
    v_mul_f32 v136, v122, v136
    v_mul_f32 v137, v122, v137
    v_mul_f32 v138, v122, v138
    v_mul_f32 v139, v122, v139
    v_cvt_pk_bf16_f32 v88, v136, v137
    v_cvt_pk_bf16_f32 v89, v138, v139
    v_mul_f32 v152, v122, v152
    v_mul_f32 v153, v122, v153
    v_mul_f32 v154, v122, v154
    v_mul_f32 v155, v122, v155
    v_cvt_pk_bf16_f32 v96, v152, v153
    v_cvt_pk_bf16_f32 v97, v154, v155
    ds_write2st64_b64 v78, v[88:89], v[96:97] offset0:0 offset1:16
    v_mul_f32 v140, v122, v140
    v_mul_f32 v141, v122, v141
    v_mul_f32 v142, v122, v142
    v_mul_f32 v143, v122, v143
    v_cvt_pk_bf16_f32 v90, v140, v141
    v_cvt_pk_bf16_f32 v91, v142, v143
    v_mul_f32 v156, v122, v156
    v_mul_f32 v157, v122, v157
    v_mul_f32 v158, v122, v158
    v_mul_f32 v159, v122, v159
    v_cvt_pk_bf16_f32 v98, v156, v157
    v_cvt_pk_bf16_f32 v99, v158, v159
    ds_write2st64_b64 v79, v[90:91], v[98:99] offset0:0 offset1:16
    ds_read_b128 v[100:103], v8 offset:0
    ds_read_b128 v[104:107], v7 offset:512
    ds_read_b128 v[108:111], v8 offset:1024
    ds_read_b128 v[112:115], v7 offset:1536
    s_waitcnt lgkmcnt(3)
    buffer_store_dwordx4 v[100:103], v6, s[24:27], s37 offen offset:0 nt
    s_waitcnt lgkmcnt(2)
    buffer_store_dwordx4 v[104:107], v6, s[24:27], s37 offen offset:1024 nt
    s_waitcnt lgkmcnt(1)
    buffer_store_dwordx4 v[108:111], v6, s[24:27], s37 offen offset:2048 nt
    s_waitcnt lgkmcnt(0)
    buffer_store_dwordx4 v[112:115], v6, s[24:27], s37 offen offset:3072 nt
    s_add_u32 s37, s37, 4096
    v_add_f32 v120, v56, v57
    v_rcp_f32 v122, v120
    s_nop 0
    v_mul_f32 v160, v122, v160
    v_mul_f32 v161, v122, v161
    v_mul_f32 v162, v122, v162
    v_mul_f32 v163, v122, v163
    v_cvt_pk_bf16_f32 v84, v160, v161
    v_cvt_pk_bf16_f32 v85, v162, v163
    v_mul_f32 v176, v122, v176
    v_mul_f32 v177, v122, v177
    v_mul_f32 v178, v122, v178
    v_mul_f32 v179, v122, v179
    v_cvt_pk_bf16_f32 v92, v176, v177
    v_cvt_pk_bf16_f32 v93, v178, v179
    ds_write2st64_b64 v76, v[84:85], v[92:93] offset0:4 offset1:20
    v_mul_f32 v164, v122, v164
    v_mul_f32 v165, v122, v165
    v_mul_f32 v166, v122, v166
    v_mul_f32 v167, v122, v167
    v_cvt_pk_bf16_f32 v86, v164, v165
    v_cvt_pk_bf16_f32 v87, v166, v167
    v_mul_f32 v180, v122, v180
    v_mul_f32 v181, v122, v181
    v_mul_f32 v182, v122, v182
    v_mul_f32 v183, v122, v183
    v_cvt_pk_bf16_f32 v94, v180, v181
    v_cvt_pk_bf16_f32 v95, v182, v183
    ds_write2st64_b64 v77, v[86:87], v[94:95] offset0:4 offset1:20
    v_mul_f32 v168, v122, v168
    v_mul_f32 v169, v122, v169
    v_mul_f32 v170, v122, v170
    v_mul_f32 v171, v122, v171
    v_cvt_pk_bf16_f32 v88, v168, v169
    v_cvt_pk_bf16_f32 v89, v170, v171
    v_mul_f32 v184, v122, v184
    v_mul_f32 v185, v122, v185
    v_mul_f32 v186, v122, v186
    v_mul_f32 v187, v122, v187
    v_cvt_pk_bf16_f32 v96, v184, v185
    v_cvt_pk_bf16_f32 v97, v186, v187
    ds_write2st64_b64 v78, v[88:89], v[96:97] offset0:4 offset1:20
    v_mul_f32 v172, v122, v172
    v_mul_f32 v173, v122, v173
    v_mul_f32 v174, v122, v174
    v_mul_f32 v175, v122, v175
    v_cvt_pk_bf16_f32 v90, v172, v173
    v_cvt_pk_bf16_f32 v91, v174, v175
    v_mul_f32 v188, v122, v188
    v_mul_f32 v189, v122, v189
    v_mul_f32 v190, v122, v190
    v_mul_f32 v191, v122, v191
    v_cvt_pk_bf16_f32 v98, v188, v189
    v_cvt_pk_bf16_f32 v99, v190, v191
    ds_write2st64_b64 v79, v[90:91], v[98:99] offset0:4 offset1:20
    ds_read_b128 v[100:103], v8 offset:2048
    ds_read_b128 v[104:107], v7 offset:2560
    ds_read_b128 v[108:111], v8 offset:3072
    ds_read_b128 v[112:115], v7 offset:3584
    s_waitcnt lgkmcnt(3)
    buffer_store_dwordx4 v[100:103], v6, s[24:27], s37 offen offset:0 nt
    s_waitcnt lgkmcnt(2)
    buffer_store_dwordx4 v[104:107], v6, s[24:27], s37 offen offset:1024 nt
    s_waitcnt lgkmcnt(1)
    buffer_store_dwordx4 v[108:111], v6, s[24:27], s37 offen offset:2048 nt
    s_waitcnt lgkmcnt(0)
    buffer_store_dwordx4 v[112:115], v6, s[24:27], s37 offen offset:3072 nt
    s_add_u32 s37, s37, 4096
    v_add_f32 v120, v60, v61
    v_rcp_f32 v122, v120
    s_nop 0
    v_mul_f32 v192, v122, v192
    v_mul_f32 v193, v122, v193
    v_mul_f32 v194, v122, v194
    v_mul_f32 v195, v122, v195
    v_cvt_pk_bf16_f32 v84, v192, v193
    v_cvt_pk_bf16_f32 v85, v194, v195
    v_mul_f32 v208, v122, v208
    v_mul_f32 v209, v122, v209
    v_mul_f32 v210, v122, v210
    v_mul_f32 v211, v122, v211
    v_cvt_pk_bf16_f32 v92, v208, v209
    v_cvt_pk_bf16_f32 v93, v210, v211
    ds_write2st64_b64 v76, v[84:85], v[92:93] offset0:8 offset1:24
    v_mul_f32 v196, v122, v196
    v_mul_f32 v197, v122, v197
    v_mul_f32 v198, v122, v198
    v_mul_f32 v199, v122, v199
    v_cvt_pk_bf16_f32 v86, v196, v197
    v_cvt_pk_bf16_f32 v87, v198, v199
    v_mul_f32 v212, v122, v212
    v_mul_f32 v213, v122, v213
    v_mul_f32 v214, v122, v214
    v_mul_f32 v215, v122, v215
    v_cvt_pk_bf16_f32 v94, v212, v213
    v_cvt_pk_bf16_f32 v95, v214, v215
    ds_write2st64_b64 v77, v[86:87], v[94:95] offset0:8 offset1:24
    v_mul_f32 v200, v122, v200
    v_mul_f32 v201, v122, v201
    v_mul_f32 v202, v122, v202
    v_mul_f32 v203, v122, v203
    v_cvt_pk_bf16_f32 v88, v200, v201
    v_cvt_pk_bf16_f32 v89, v202, v203
    v_mul_f32 v216, v122, v216
    v_mul_f32 v217, v122, v217
    v_mul_f32 v218, v122, v218
    v_mul_f32 v219, v122, v219
    v_cvt_pk_bf16_f32 v96, v216, v217
    v_cvt_pk_bf16_f32 v97, v218, v219
    ds_write2st64_b64 v78, v[88:89], v[96:97] offset0:8 offset1:24
    v_mul_f32 v204, v122, v204
    v_mul_f32 v205, v122, v205
    v_mul_f32 v206, v122, v206
    v_mul_f32 v207, v122, v207
    v_cvt_pk_bf16_f32 v90, v204, v205
    v_cvt_pk_bf16_f32 v91, v206, v207
    v_mul_f32 v220, v122, v220
    v_mul_f32 v221, v122, v221
    v_mul_f32 v222, v122, v222
    v_mul_f32 v223, v122, v223
    v_cvt_pk_bf16_f32 v98, v220, v221
    v_cvt_pk_bf16_f32 v99, v222, v223
    ds_write2st64_b64 v79, v[90:91], v[98:99] offset0:8 offset1:24
    ds_read_b128 v[100:103], v8 offset:4096
    ds_read_b128 v[104:107], v7 offset:4608
    ds_read_b128 v[108:111], v8 offset:5120
    ds_read_b128 v[112:115], v7 offset:5632
    s_waitcnt lgkmcnt(3)
    buffer_store_dwordx4 v[100:103], v6, s[24:27], s37 offen offset:0 nt
    s_waitcnt lgkmcnt(2)
    buffer_store_dwordx4 v[104:107], v6, s[24:27], s37 offen offset:1024 nt
    s_waitcnt lgkmcnt(1)
    buffer_store_dwordx4 v[108:111], v6, s[24:27], s37 offen offset:2048 nt
    s_waitcnt lgkmcnt(0)
    buffer_store_dwordx4 v[112:115], v6, s[24:27], s37 offen offset:3072 nt
    s_add_u32 s37, s37, 4096
    v_add_f32 v120, v64, v65
    v_rcp_f32 v122, v120
    s_nop 0
    v_mul_f32 v224, v122, v224
    v_mul_f32 v225, v122, v225
    v_mul_f32 v226, v122, v226
    v_mul_f32 v227, v122, v227
    v_cvt_pk_bf16_f32 v84, v224, v225
    v_cvt_pk_bf16_f32 v85, v226, v227
    v_mul_f32 v240, v122, v240
    v_mul_f32 v241, v122, v241
    v_mul_f32 v242, v122, v242
    v_mul_f32 v243, v122, v243
    v_cvt_pk_bf16_f32 v92, v240, v241
    v_cvt_pk_bf16_f32 v93, v242, v243
    ds_write2st64_b64 v76, v[84:85], v[92:93] offset0:12 offset1:28
    v_mul_f32 v228, v122, v228
    v_mul_f32 v229, v122, v229
    v_mul_f32 v230, v122, v230
    v_mul_f32 v231, v122, v231
    v_cvt_pk_bf16_f32 v86, v228, v229
    v_cvt_pk_bf16_f32 v87, v230, v231
    v_mul_f32 v244, v122, v244
    v_mul_f32 v245, v122, v245
    v_mul_f32 v246, v122, v246
    v_mul_f32 v247, v122, v247
    v_cvt_pk_bf16_f32 v94, v244, v245
    v_cvt_pk_bf16_f32 v95, v246, v247
    ds_write2st64_b64 v77, v[86:87], v[94:95] offset0:12 offset1:28
    v_mul_f32 v232, v122, v232
    v_mul_f32 v233, v122, v233
    v_mul_f32 v234, v122, v234
    v_mul_f32 v235, v122, v235
    v_cvt_pk_bf16_f32 v88, v232, v233
    v_cvt_pk_bf16_f32 v89, v234, v235
    v_mul_f32 v248, v122, v248
    v_mul_f32 v249, v122, v249
    v_mul_f32 v250, v122, v250
    v_mul_f32 v251, v122, v251
    v_cvt_pk_bf16_f32 v96, v248, v249
    v_cvt_pk_bf16_f32 v97, v250, v251
    ds_write2st64_b64 v78, v[88:89], v[96:97] offset0:12 offset1:28
    v_mul_f32 v236, v122, v236
    v_mul_f32 v237, v122, v237
    v_mul_f32 v238, v122, v238
    v_mul_f32 v239, v122, v239
    v_cvt_pk_bf16_f32 v90, v236, v237
    v_cvt_pk_bf16_f32 v91, v238, v239
    v_mul_f32 v252, v122, v252
    v_mul_f32 v253, v122, v253
    v_mul_f32 v254, v122, v254
    v_mul_f32 v255, v122, v255
    v_cvt_pk_bf16_f32 v98, v252, v253
    v_cvt_pk_bf16_f32 v99, v254, v255
    ds_write2st64_b64 v79, v[90:91], v[98:99] offset0:12 offset1:28
    ds_read_b128 v[100:103], v8 offset:6144
    ds_read_b128 v[104:107], v7 offset:6656
    ds_read_b128 v[108:111], v8 offset:7168
    ds_read_b128 v[112:115], v7 offset:7680
    s_waitcnt lgkmcnt(3)
    buffer_store_dwordx4 v[100:103], v6, s[24:27], s37 offen offset:0 nt
    s_waitcnt lgkmcnt(2)
    buffer_store_dwordx4 v[104:107], v6, s[24:27], s37 offen offset:1024 nt
    s_waitcnt lgkmcnt(1)
    buffer_store_dwordx4 v[108:111], v6, s[24:27], s37 offen offset:2048 nt
    s_waitcnt lgkmcnt(0)
    buffer_store_dwordx4 v[112:115], v6, s[24:27], s37 offen offset:3072 nt
    s_add_u32 s37, s37, 4096
    s_mov_b32 s37, 131072
    s_cmp_lt_u32 s33, 524288
    s_cbranch_scc1 FB_BLK
    s_endpgm
.section .rodata,"a"
.p2align 6
.amdhsa_kernel standalone__gqa_softmax__near_ridge_kernel
  .amdhsa_next_free_vgpr 512
  .amdhsa_next_free_sgpr 102
  .amdhsa_accum_offset 256
  .amdhsa_group_segment_fixed_size 0
  .amdhsa_kernarg_size 48
  .amdhsa_user_sgpr_count 2
  .amdhsa_user_sgpr_kernarg_segment_ptr 1
  .amdhsa_system_sgpr_workgroup_id_x 1
.end_amdhsa_kernel
```
